```python
import torch

def _softmax(x, axis=-1):
    return torch.softmax(x, dim=axis)
def _gelu(x):
    return torch.nn.functional.gelu(x, approximate="tanh")
def _silu(x):
    return torch.nn.functional.silu(x)
def _sigmoid(x):
    return torch.sigmoid(x)
def _layernorm(x, axis=-1, eps=1e-5):
    m = x.mean(dim=axis, keepdim=True)
    v = x.var(dim=axis, keepdim=True, unbiased=False)
    return (x - m) / torch.sqrt(v + eps)
def _scatter_add(tgt, idx, src, axis=0):
    return tgt.clone().index_add_(axis, idx, src)
def _segment_sum(src, seg, n):
    out = torch.zeros((n,) + src.shape[1:], dtype=src.dtype)
    return out.index_add_(0, seg, src)
def _pad(x, pw):
    flat = tuple(v for pair in reversed(pw) for v in pair)
    return torch.nn.functional.pad(x, flat)

kernel_name = 'gather_scatter__cheap_equivariant_egnn__graph'

def setup_inputs():

    _w = (lambda a: (lambda t: t.to(torch.bfloat16) if t.is_floating_point() else t)(torch.as_tensor(a)))
    N, deg, D, De = 10000, 16, 256, max(16, 1)
    E = N * deg
    return {
        "h": _w((lambda *s: torch.randn(*s, dtype=torch.bfloat16) * 0.1)(N, D)),
        "pos": _w((lambda *s: torch.randn(*s, dtype=torch.bfloat16) * 0.8)(N, 3)),
        "e_attr": _w((lambda *s: torch.randn(*s, dtype=torch.bfloat16) * 0.8)(E, De)),
        "src": _w((lambda lo, hi, *s: torch.randint(lo, hi, s))(0, N, E).to(torch.int64)),
        "dst": _w((lambda lo, hi, *s: torch.randint(lo, hi, s))(0, N, E).to(torch.int64)),
        "w_e": _w(0.1 * (lambda *s: torch.randn(*s, dtype=torch.bfloat16) * 0.8)(2 * D + 1 + De, D)),
        "w_x": _w(0.1 * (lambda *s: torch.randn(*s, dtype=torch.bfloat16) * 0.1)(D, 1)),
        "w_h": _w(0.1 * (lambda *s: torch.randn(*s, dtype=torch.bfloat16) * 0.1)(2 * D, D)),
    }

def reference(h, pos, e_attr, src, dst, w_e, w_x, w_h):
    N, D = h.shape[0], h.shape[1]
    diff = pos[dst] - pos[src]
    dist2 = torch.sum(diff * diff, axis=-1, keepdims=True)
    e_in = torch.concatenate([h[dst], h[src], dist2, e_attr], axis=-1)
    m_ij = _silu(e_in @ w_e)
    coord_scale = m_ij @ w_x
    pos_new = pos + _segment_sum(diff * coord_scale, dst, N)
    m_i = _segment_sum(m_ij, dst, N)
    h_new = h + _silu(torch.concatenate([h, m_i], axis=-1) @ w_h)
    return h_new, pos_new
```

```asm
; @launch kernel=k1_prep_kernel grid=(256,1,1) block=(256,1,1) lds=163840
; @launch kernel=k2_main_kernel grid=(250,1,1) block=(512,1,1) lds=163808
.amdgcn_target "amdgcn-amd-amdhsa--gfx950"
.text
.globl k1_prep_kernel
.p2align 8
.type k1_prep_kernel,@function
k1_prep_kernel:
    s_cmp_ge_u32 s2, 256
    s_cbranch_scc1 k1_done
    s_load_dwordx16 s[16:31], s[0:1], 0
    s_load_dwordx4 s[32:35], s[0:1], 64
    s_load_dwordx2 s[36:37], s[0:1], 80
    s_getpc_b64 s[70:71]
k1_pc1:
    s_add_u32 s70, s70, k1_prep_kernel-k1_pc1
    s_addc_u32 s71, s71, -1
    s_lshr_b32 s72, s2, 3
    s_and_b32 s72, s72, 15
    s_lshl_b32 s72, s72, 10
    v_lshlrev_b32 v36, 2, v0
    v_add_u32 v36, s72, v36
    global_load_dword v240, v36, s[70:71]
    v_and_b32 v1, 63, v0
    v_lshrrev_b32 v2, 6, v0
    s_nop 0
    v_readfirstlane_b32 s3, v2
    s_and_b32 s4, s2, 7
    s_lshr_b32 s5, s2, 3
    s_and_b32 s6, s5, 3
    s_lshr_b32 s5, s5, 2
    s_lshl_b32 s5, s5, 3
    s_add_u32 s7, s4, s5
    s_waitcnt lgkmcnt(0)
    s_mov_b32 s40, s24
    s_mov_b32 s41, s25
    s_mov_b32 s42, 640000
    s_mov_b32 s43, 0x20000
    s_mov_b32 s44, s22
    s_mov_b32 s45, s23
    s_mov_b32 s46, 640000
    s_mov_b32 s47, 0x20000
    s_mov_b32 s48, s16
    s_mov_b32 s49, s17
    s_mov_b32 s50, 5120000
    s_mov_b32 s51, 0x20000
    s_mov_b32 s52, s26
    s_mov_b32 s53, s27
    s_mov_b32 s54, 270848
    s_mov_b32 s55, 0x20000
    s_mov_b32 s56, s30
    s_mov_b32 s57, s31
    s_mov_b32 s58, 262144
    s_mov_b32 s59, 0x20000
    s_mov_b32 s60, s36
    s_mov_b32 s61, s37
    s_mov_b32 s62, 33554432
    s_mov_b32 s63, 0x20000
    s_mov_b32 s64, s36
    s_mov_b32 s65, s37
    s_mov_b32 s66, 5120000
    s_mov_b32 s67, 0x20000
    s_mul_i32 s8, s2, 2560
    v_lshlrev_b32 v3, 2, v0
    s_cmp_ge_u32 s2, 250
    s_cbranch_scc1 k1_nopl
    buffer_load_dword v10, v3, s[40:43], s8 offen offset:0
    buffer_load_dword v13, v3, s[44:47], s8 offen offset:0
    buffer_load_dword v11, v3, s[40:43], s8 offen offset:1024
    buffer_load_dword v14, v3, s[44:47], s8 offen offset:1024
    buffer_load_dword v12, v3, s[40:43], s8 offen offset:2048
    buffer_load_dword v15, v3, s[44:47], s8 offen offset:2048
k1_nopl:
    s_cmp_eq_u32 s3, 1
    s_cbranch_scc0 k1_nopk1
    s_lshr_b32 s9, s2, 5
    s_lshr_b32 s10, s2, 1
    s_and_b32 s10, s10, 15
    s_and_b32 s11, s2, 1
    s_lshl_b32 s9, s9, 5
    s_add_u32 s9, s9, s11
    v_and_b32 v4, 15, v1
    v_lshrrev_b32 v5, 4, v1
    v_lshlrev_b32 v4, 1, v4
    v_add_u32 v4, s9, v4
    v_lshlrev_b32 v4, 1, v4
    s_cmp_lt_u32 s10, 8
    s_cbranch_scc0 k1_pk_m
    s_lshl_b32 s12, s10, 5
    v_lshlrev_b32 v5, 3, v5
    v_add_u32 v5, s12, v5
    v_lshl_add_u32 v4, v5, 9, v4
    buffer_load_ushort v16, v4, s[56:59], 0 offen offset:0
    buffer_load_ushort v17, v4, s[56:59], 0 offen offset:512
    buffer_load_ushort v18, v4, s[56:59], 0 offen offset:1024
    buffer_load_ushort v19, v4, s[56:59], 0 offen offset:1536
    buffer_load_ushort v20, v4, s[56:59], 0 offen offset:2048
    buffer_load_ushort v21, v4, s[56:59], 0 offen offset:2560
    buffer_load_ushort v22, v4, s[56:59], 0 offen offset:3072
    buffer_load_ushort v23, v4, s[56:59], 0 offen offset:3584
    s_branch k1_nopk
k1_pk_m:
    s_sub_u32 s12, s10, 8
    s_lshl_b32 s12, s12, 4
    v_lshlrev_b32 v5, 2, v5
    v_add_u32 v5, s12, v5
    v_and_b32 v6, 31, v5
    v_and_b32 v5, 0xffe0, v5
    v_lshl_add_u32 v5, v5, 1, v6
    v_add_u32 v5, 256, v5
    v_lshl_add_u32 v4, v5, 9, v4
    v_add_u32 v6, 16384, v4
    buffer_load_ushort v16, v4, s[56:59], 0 offen offset:0
    buffer_load_ushort v17, v6, s[56:59], 0 offen offset:0
    buffer_load_ushort v18, v4, s[56:59], 0 offen offset:512
    buffer_load_ushort v19, v6, s[56:59], 0 offen offset:512
    buffer_load_ushort v20, v4, s[56:59], 0 offen offset:1024
    buffer_load_ushort v21, v6, s[56:59], 0 offen offset:1024
    buffer_load_ushort v22, v4, s[56:59], 0 offen offset:1536
    buffer_load_ushort v23, v6, s[56:59], 0 offen offset:1536
    s_branch k1_nopk
k1_nopk1:
    s_cmp_eq_u32 s3, 2
    s_cbranch_scc0 k1_nopk
    s_cmp_lt_u32 s2, 12
    s_cbranch_scc0 k1_nopk
    s_cmp_lt_u32 s2, 8
    s_cbranch_scc0 k1_pk_wd
    v_and_b32 v4, 31, v1
    v_lshrrev_b32 v5, 5, v1
    s_lshl_b32 s9, s2, 5
    v_add_u32 v4, s9, v4
    v_lshlrev_b32 v4, 1, v4
    v_lshlrev_b32 v5, 3, v5
    v_add_u32 v5, 513, v5
    v_lshl_add_u32 v4, v5, 9, v4
    buffer_load_ushort v16, v4, s[52:55], 0 offen offset:0
    buffer_load_ushort v17, v4, s[52:55], 0 offen offset:512
    buffer_load_ushort v18, v4, s[52:55], 0 offen offset:1024
    buffer_load_ushort v19, v4, s[52:55], 0 offen offset:1536
    buffer_load_ushort v20, v4, s[52:55], 0 offen offset:2048
    buffer_load_ushort v21, v4, s[52:55], 0 offen offset:2560
    buffer_load_ushort v22, v4, s[52:55], 0 offen offset:3072
    buffer_load_ushort v23, v4, s[52:55], 0 offen offset:3584
    s_branch k1_nopk
k1_pk_wd:
    s_sub_u32 s9, s2, 8
    s_lshl_b32 s9, s9, 6
    v_add_u32 v4, s9, v1
    v_lshlrev_b32 v4, 1, v4
    v_add_u32 v4, 0x40000, v4
    buffer_load_ushort v16, v4, s[52:55], 0 offen
k1_nopk:
    s_cmp_ge_u32 s7, 63
    s_cbranch_scc1 k1_nodma
    v_lshrrev_b32 v4, 4, v1
    v_and_b32 v5, 15, v1
    v_lshlrev_b32 v6, 2, v4
    v_xor_b32 v5, v5, v6
    v_lshlrev_b32 v5, 4, v5
    v_lshl_add_u32 v30, v4, 9, v5
    v_lshrrev_b32 v4, 3, v1
    v_and_b32 v5, 7, v1
    v_lshrrev_b32 v6, 1, v4
    v_xor_b32 v5, v5, v6
    v_lshlrev_b32 v5, 4, v5
    v_lshl_add_u32 v31, v4, 9, v5
    v_xor_b32 v32, 64, v31
    s_lshr_b32 s9, s6, 1
    s_lshl_b32 s9, s9, 17
    s_and_b32 s10, s6, 1
    s_lshl_b32 s10, s10, 8
    s_add_u32 s9, s9, s10
    s_lshl_b32 s10, s3, 13
    s_add_u32 s9, s9, s10
    s_lshl_b32 s10, s3, 12
    s_add_u32 s10, s10, 81920
    s_mul_i32 s11, s7, 160
    s_mul_i32 s12, s3, 40
    s_add_u32 s11, s11, s12
    s_lshl_b32 s11, s11, 9
    s_mul_i32 s12, s3, 5120
    s_and_b32 s13, s3, 1
    s_lshl_b32 s13, s13, 6
    v_xor_b32 v33, s13, v31
    v_xor_b32 v34, 64, v33
    s_add_u32 s14, s9, 0
    s_add_u32 m0, s10, 0
    s_nop 0
    buffer_load_dwordx4 v30, s[52:55], s14 offen lds
    s_add_u32 s14, s9, 2048
    s_add_u32 m0, s10, 1024
    s_nop 0
    buffer_load_dwordx4 v30, s[52:55], s14 offen lds
    s_add_u32 s14, s9, 4096
    s_add_u32 m0, s10, 2048
    s_nop 0
    buffer_load_dwordx4 v30, s[52:55], s14 offen lds
    s_add_u32 s14, s9, 6144
    s_add_u32 m0, s10, 3072
    s_nop 0
    buffer_load_dwordx4 v30, s[52:55], s14 offen lds
    s_add_u32 s14, s11, 0
    s_add_u32 m0, s12, 0
    s_nop 0
    buffer_load_dwordx4 v33, s[48:51], s14 offen lds
    s_add_u32 s14, s11, 4096
    s_add_u32 m0, s12, 1024
    s_nop 0
    buffer_load_dwordx4 v34, s[48:51], s14 offen lds
    s_add_u32 s14, s11, 8192
    s_add_u32 m0, s12, 2048
    s_nop 0
    buffer_load_dwordx4 v33, s[48:51], s14 offen lds
    s_add_u32 s14, s11, 12288
    s_add_u32 m0, s12, 3072
    s_nop 0
    buffer_load_dwordx4 v34, s[48:51], s14 offen lds
    s_add_u32 s14, s11, 16384
    s_add_u32 m0, s12, 4096
    s_nop 0
    buffer_load_dwordx4 v33, s[48:51], s14 offen lds
    s_add_u32 s14, s9, 32768
    s_add_u32 m0, s10, 16384
    s_nop 0
    buffer_load_dwordx4 v30, s[52:55], s14 offen lds
    s_add_u32 s14, s9, 34816
    s_add_u32 m0, s10, 17408
    s_nop 0
    buffer_load_dwordx4 v30, s[52:55], s14 offen lds
    s_add_u32 s14, s9, 36864
    s_add_u32 m0, s10, 18432
    s_nop 0
    buffer_load_dwordx4 v30, s[52:55], s14 offen lds
    s_add_u32 s14, s9, 38912
    s_add_u32 m0, s10, 19456
    s_nop 0
    buffer_load_dwordx4 v30, s[52:55], s14 offen lds
    s_add_u32 s14, s11, 128
    s_add_u32 m0, s12, 20480
    s_nop 0
    buffer_load_dwordx4 v33, s[48:51], s14 offen lds
    s_add_u32 s14, s11, 4224
    s_add_u32 m0, s12, 21504
    s_nop 0
    buffer_load_dwordx4 v34, s[48:51], s14 offen lds
    s_add_u32 s14, s11, 8320
    s_add_u32 m0, s12, 22528
    s_nop 0
    buffer_load_dwordx4 v33, s[48:51], s14 offen lds
    s_add_u32 s14, s11, 12416
    s_add_u32 m0, s12, 23552
    s_nop 0
    buffer_load_dwordx4 v34, s[48:51], s14 offen lds
    s_add_u32 s14, s11, 16512
    s_add_u32 m0, s12, 24576
    s_nop 0
    buffer_load_dwordx4 v33, s[48:51], s14 offen lds
    s_add_u32 s14, s9, 65536
    s_add_u32 m0, s10, 32768
    s_nop 0
    buffer_load_dwordx4 v30, s[52:55], s14 offen lds
    s_add_u32 s14, s9, 67584
    s_add_u32 m0, s10, 33792
    s_nop 0
    buffer_load_dwordx4 v30, s[52:55], s14 offen lds
    s_add_u32 s14, s9, 69632
    s_add_u32 m0, s10, 34816
    s_nop 0
    buffer_load_dwordx4 v30, s[52:55], s14 offen lds
    s_add_u32 s14, s9, 71680
    s_add_u32 m0, s10, 35840
    s_nop 0
    buffer_load_dwordx4 v30, s[52:55], s14 offen lds
    s_add_u32 s14, s11, 256
    s_add_u32 m0, s12, 40960
    s_nop 0
    buffer_load_dwordx4 v33, s[48:51], s14 offen lds
    s_add_u32 s14, s11, 4352
    s_add_u32 m0, s12, 41984
    s_nop 0
    buffer_load_dwordx4 v34, s[48:51], s14 offen lds
    s_add_u32 s14, s11, 8448
    s_add_u32 m0, s12, 43008
    s_nop 0
    buffer_load_dwordx4 v33, s[48:51], s14 offen lds
    s_add_u32 s14, s11, 12544
    s_add_u32 m0, s12, 44032
    s_nop 0
    buffer_load_dwordx4 v34, s[48:51], s14 offen lds
    s_add_u32 s14, s11, 16640
    s_add_u32 m0, s12, 45056
    s_nop 0
    buffer_load_dwordx4 v33, s[48:51], s14 offen lds
    s_add_u32 s14, s9, 98304
    s_add_u32 m0, s10, 49152
    s_nop 0
    buffer_load_dwordx4 v30, s[52:55], s14 offen lds
    s_add_u32 s14, s9, 100352
    s_add_u32 m0, s10, 50176
    s_nop 0
    buffer_load_dwordx4 v30, s[52:55], s14 offen lds
    s_add_u32 s14, s9, 102400
    s_add_u32 m0, s10, 51200
    s_nop 0
    buffer_load_dwordx4 v30, s[52:55], s14 offen lds
    s_add_u32 s14, s9, 104448
    s_add_u32 m0, s10, 52224
    s_nop 0
    buffer_load_dwordx4 v30, s[52:55], s14 offen lds
    s_add_u32 s14, s11, 384
    s_add_u32 m0, s12, 61440
    s_nop 0
    buffer_load_dwordx4 v33, s[48:51], s14 offen lds
    s_add_u32 s14, s11, 4480
    s_add_u32 m0, s12, 62464
    s_nop 0
    buffer_load_dwordx4 v34, s[48:51], s14 offen lds
    s_add_u32 s14, s11, 8576
    s_add_u32 m0, s12, 63488
    s_nop 0
    buffer_load_dwordx4 v33, s[48:51], s14 offen lds
    s_add_u32 s14, s11, 12672
    s_add_u32 m0, s12, 64512
    s_nop 0
    buffer_load_dwordx4 v34, s[48:51], s14 offen lds
    s_add_u32 s14, s11, 16768
    s_add_u32 m0, s12, 65536
    s_nop 0
    buffer_load_dwordx4 v33, s[48:51], s14 offen lds
k1_nodma:
    s_mov_b32 s68, s20
    s_mov_b32 s69, s21
    s_mov_b32 s70, 5120000
    s_mov_b32 s71, 0x20000
    s_mul_i32 s38, s2, 20000
    v_lshlrev_b32 v36, 4, v0
    v_add_u32 v36, s38, v36
    buffer_load_dwordx4 v[200:203], v36, s[68:71], 0 offen
    v_add_u32 v36, 4096, v36
    buffer_load_dwordx4 v[204:207], v36, s[68:71], 0 offen
    v_add_u32 v36, 4096, v36
    buffer_load_dwordx4 v[208:211], v36, s[68:71], 0 offen
    v_add_u32 v36, 4096, v36
    buffer_load_dwordx4 v[212:215], v36, s[68:71], 0 offen
    v_add_u32 v36, 4096, v36
    buffer_load_dwordx4 v[216:219], v36, s[68:71], 0 offen
    s_mov_b32 s68, s18
    s_mov_b32 s69, s19
    s_mov_b32 s70, 60000
    s_mov_b32 s71, 0x20000
    s_lshl_b32 s38, s2, 8
    v_lshlrev_b32 v36, 2, v1
    buffer_load_dword v241, v36, s[68:71], s38 offen
    s_cmp_eq_u32 s3, 3
    s_cbranch_scc0 k1_nocpf
    s_getpc_b64 s[70:71]
k1_pc:
    s_add_u32 s70, s70, k2_main_kernel-k1_pc
    s_addc_u32 s71, s71, 0
    s_lshr_b32 s72, s2, 3
    s_and_b32 s72, s72, 31
    s_lshl_b32 s72, s72, 10
    v_lshlrev_b32 v36, 4, v1
    v_add_u32 v36, s72, v36
    global_load_dwordx4 v[240:243], v36, s[70:71]
k1_nocpf:
    v_lshlrev_b32 v4, 6, v0
    v_add_u32 v4, 147456, v4
    v_mov_b32 v5, 0
    v_cmp_eq_u32 vcc, 250, v0
    v_mov_b32 v6, 163456
    s_nop 0
    v_cndmask_b32 v4, v4, v6, vcc
    v_cmp_gt_u32 vcc, 251, v0
    s_nop 0
    s_and_saveexec_b64 s[14:15], vcc
    ds_write_b32 v4, v5
    s_mov_b64 exec, s[14:15]
    s_cmp_eq_u32 s3, 1
    s_cbranch_scc0 k1_nops1
    s_cmp_ge_u32 s7, 63
    s_cbranch_scc1 k1_w1a
    s_waitcnt vmcnt(36)
    s_branch k1_w1b
k1_w1a:
    s_waitcnt vmcnt(0)
k1_w1b:
    s_lshl_b32 s38, s2, 10
    s_add_u32 s38, s38, 16121856
    v_lshlrev_b32 v4, 4, v1
    v_lshl_or_b32 v16, v17, 16, v16
    v_lshl_or_b32 v17, v19, 16, v18
    v_lshl_or_b32 v18, v21, 16, v20
    v_lshl_or_b32 v19, v23, 16, v22
    buffer_store_dwordx4 v[16:19], v4, s[60:63], s38 offen sc0 sc1
    s_branch k1_nops
k1_nops1:
    s_cmp_eq_u32 s3, 2
    s_cbranch_scc0 k1_nops
    s_cmp_lt_u32 s2, 12
    s_cbranch_scc0 k1_nops
    s_waitcnt vmcnt(36)
    s_mov_b32 s38, 0xbfb8aa3b
    s_cmp_lt_u32 s2, 8
    s_cbranch_scc0 k1_ps_wd
    v_lshlrev_b32 v16, 16, v16
    v_mul_f32 v16, s38, v16
    v_lshlrev_b32 v17, 16, v17
    v_mul_f32 v17, s38, v17
    v_lshlrev_b32 v18, 16, v18
    v_mul_f32 v18, s38, v18
    v_lshlrev_b32 v19, 16, v19
    v_mul_f32 v19, s38, v19
    v_lshlrev_b32 v20, 16, v20
    v_mul_f32 v20, s38, v20
    v_lshlrev_b32 v21, 16, v21
    v_mul_f32 v21, s38, v21
    v_lshlrev_b32 v22, 16, v22
    v_mul_f32 v22, s38, v22
    v_lshlrev_b32 v23, 16, v23
    v_mul_f32 v23, s38, v23
    v_cvt_pk_bf16_f32 v16, v16, v17
    v_cvt_pk_bf16_f32 v17, v18, v19
    v_cvt_pk_bf16_f32 v18, v20, v21
    v_cvt_pk_bf16_f32 v19, v22, v23
    s_lshl_b32 s39, s2, 10
    s_add_u32 s39, s39, 16056320
    v_lshlrev_b32 v4, 4, v1
    buffer_store_dwordx4 v[16:19], v4, s[60:63], s39 offen sc0 sc1
    s_branch k1_nops
k1_ps_wd:
    v_lshlrev_b32 v16, 16, v16
    v_mul_f32 v16, s38, v16
    v_mov_b32 v17, 0
    v_cvt_pk_bf16_f32 v16, v16, v17
    v_mov_b32 v18, 0
    v_mov_b32 v19, 0
    s_sub_u32 s39, s2, 8
    s_lshl_b32 s39, s39, 10
    s_add_u32 s39, s39, 16064512
    v_lshlrev_b32 v4, 4, v1
    buffer_store_dwordx4 v[16:19], v4, s[60:63], s39 offen sc0 sc1
k1_nops:
    s_waitcnt lgkmcnt(0)
    s_cmp_ge_u32 s7, 63
    s_cbranch_scc1 k1_b1a
    s_waitcnt vmcnt(27)
k1_b1a:
    s_barrier
    s_cmp_ge_u32 s7, 63
    s_cbranch_scc1 k1_part
    v_and_b32 v4, 31, v1
    v_lshrrev_b32 v5, 5, v1
    s_cmp_lt_u32 s6, 2
    s_cbranch_scc0 k1_rho_id
    v_lshrrev_b32 v6, 4, v4
    v_lshlrev_b32 v6, 4, v6
    v_bfe_u32 v7, v4, 2, 1
    v_lshl_add_u32 v6, v7, 3, v6
    v_bfe_u32 v7, v4, 3, 1
    v_lshl_add_u32 v6, v7, 2, v6
    v_and_b32 v7, 3, v4
    v_add_u32 v4, v6, v7
k1_rho_id:
    v_bfe_u32 v6, v4, 1, 3
    v_xor_b32 v6, v6, v5
    v_lshlrev_b32 v6, 4, v6
    v_lshl_add_u32 v40, v4, 7, v6
    v_xor_b32 v41, 32, v40
    v_xor_b32 v42, 64, v40
    v_xor_b32 v43, 96, v40
    v_bfe_u32 v6, v1, 4, 1
    v_bfe_u32 v7, v1, 2, 2
    v_bfe_u32 v8, v1, 1, 1
    v_lshl_add_u32 v8, v6, 1, v8
    s_lshl_b32 s38, s3, 2
    v_add_u32 v8, s38, v8
    v_lshlrev_b32 v9, 2, v7
    v_xor_b32 v8, v8, v9
    v_lshlrev_b32 v8, 4, v8
    v_lshl_add_u32 v9, v5, 3, v7
    v_lshl_add_u32 v8, v9, 8, v8
    v_and_b32 v9, 1, v1
    v_lshl_add_u32 v8, v9, 3, v8
    v_add_u32 v44, 81920, v8
    s_cmp_lt_u32 s6, 2
    s_cbranch_scc0 k1_gemmB
    ds_read_b64_tr_b16 v[164:165], v44 offset:0
    ds_read_b64_tr_b16 v[166:167], v44 offset:1024
    ds_read_b128 v[144:147], v40 offset:0
    ds_read_b128 v[148:151], v40 offset:4096
    ds_read_b128 v[152:155], v40 offset:8192
    ds_read_b128 v[156:159], v40 offset:12288
    ds_read_b128 v[160:163], v40 offset:16384
    ds_read_b64_tr_b16 v[188:189], v44 offset:4096
    ds_read_b64_tr_b16 v[190:191], v44 offset:5120
    ds_read_b128 v[168:171], v41 offset:0
    ds_read_b128 v[172:175], v41 offset:4096
    ds_read_b128 v[176:179], v41 offset:8192
    ds_read_b128 v[180:183], v41 offset:12288
    ds_read_b128 v[184:187], v41 offset:16384
    s_waitcnt lgkmcnt(7)
    v_mfma_f32_32x32x16_bf16 v[64:79], v[144:147], v[164:167], 0
    v_mfma_f32_32x32x16_bf16 v[80:95], v[148:151], v[164:167], 0
    v_mfma_f32_32x32x16_bf16 v[96:111], v[152:155], v[164:167], 0
    v_mfma_f32_32x32x16_bf16 v[112:127], v[156:159], v[164:167], 0
    v_mfma_f32_32x32x16_bf16 v[128:143], v[160:163], v[164:167], 0
    ds_read_b64_tr_b16 v[164:165], v44 offset:8192
    ds_read_b64_tr_b16 v[166:167], v44 offset:9216
    ds_read_b128 v[144:147], v42 offset:0
    ds_read_b128 v[148:151], v42 offset:4096
    ds_read_b128 v[152:155], v42 offset:8192
    ds_read_b128 v[156:159], v42 offset:12288
    ds_read_b128 v[160:163], v42 offset:16384
    s_waitcnt lgkmcnt(7)
    v_mfma_f32_32x32x16_bf16 v[64:79], v[168:171], v[188:191], v[64:79]
    v_mfma_f32_32x32x16_bf16 v[80:95], v[172:175], v[188:191], v[80:95]
    v_mfma_f32_32x32x16_bf16 v[96:111], v[176:179], v[188:191], v[96:111]
    v_mfma_f32_32x32x16_bf16 v[112:127], v[180:183], v[188:191], v[112:127]
    v_mfma_f32_32x32x16_bf16 v[128:143], v[184:187], v[188:191], v[128:143]
    ds_read_b64_tr_b16 v[188:189], v44 offset:12288
    ds_read_b64_tr_b16 v[190:191], v44 offset:13312
    ds_read_b128 v[168:171], v43 offset:0
    ds_read_b128 v[172:175], v43 offset:4096
    ds_read_b128 v[176:179], v43 offset:8192
    ds_read_b128 v[180:183], v43 offset:12288
    ds_read_b128 v[184:187], v43 offset:16384
    s_waitcnt lgkmcnt(7)
    v_mfma_f32_32x32x16_bf16 v[64:79], v[144:147], v[164:167], v[64:79]
    v_mfma_f32_32x32x16_bf16 v[80:95], v[148:151], v[164:167], v[80:95]
    v_mfma_f32_32x32x16_bf16 v[96:111], v[152:155], v[164:167], v[96:111]
    v_mfma_f32_32x32x16_bf16 v[112:127], v[156:159], v[164:167], v[112:127]
    v_mfma_f32_32x32x16_bf16 v[128:143], v[160:163], v[164:167], v[128:143]
    s_waitcnt lgkmcnt(0)
    v_mfma_f32_32x32x16_bf16 v[64:79], v[168:171], v[188:191], v[64:79]
    v_mfma_f32_32x32x16_bf16 v[80:95], v[172:175], v[188:191], v[80:95]
    v_mfma_f32_32x32x16_bf16 v[96:111], v[176:179], v[188:191], v[96:111]
    v_mfma_f32_32x32x16_bf16 v[112:127], v[180:183], v[188:191], v[112:127]
    v_mfma_f32_32x32x16_bf16 v[128:143], v[184:187], v[188:191], v[128:143]
    s_waitcnt vmcnt(18)
    s_barrier
    ds_read_b64_tr_b16 v[164:165], v44 offset:16384
    ds_read_b64_tr_b16 v[166:167], v44 offset:17408
    ds_read_b128 v[144:147], v40 offset:20480
    ds_read_b128 v[148:151], v40 offset:24576
    ds_read_b128 v[152:155], v40 offset:28672
    ds_read_b128 v[156:159], v40 offset:32768
    ds_read_b128 v[160:163], v40 offset:36864
    ds_read_b64_tr_b16 v[188:189], v44 offset:20480
    ds_read_b64_tr_b16 v[190:191], v44 offset:21504
    ds_read_b128 v[168:171], v41 offset:20480
    ds_read_b128 v[172:175], v41 offset:24576
    ds_read_b128 v[176:179], v41 offset:28672
    ds_read_b128 v[180:183], v41 offset:32768
    ds_read_b128 v[184:187], v41 offset:36864
    s_waitcnt lgkmcnt(7)
    v_mfma_f32_32x32x16_bf16 v[64:79], v[144:147], v[164:167], v[64:79]
    v_mfma_f32_32x32x16_bf16 v[80:95], v[148:151], v[164:167], v[80:95]
    v_mfma_f32_32x32x16_bf16 v[96:111], v[152:155], v[164:167], v[96:111]
    v_mfma_f32_32x32x16_bf16 v[112:127], v[156:159], v[164:167], v[112:127]
    v_mfma_f32_32x32x16_bf16 v[128:143], v[160:163], v[164:167], v[128:143]
    ds_read_b64_tr_b16 v[164:165], v44 offset:24576
    ds_read_b64_tr_b16 v[166:167], v44 offset:25600
    ds_read_b128 v[144:147], v42 offset:20480
    ds_read_b128 v[148:151], v42 offset:24576
    ds_read_b128 v[152:155], v42 offset:28672
    ds_read_b128 v[156:159], v42 offset:32768
    ds_read_b128 v[160:163], v42 offset:36864
    s_waitcnt lgkmcnt(7)
    v_mfma_f32_32x32x16_bf16 v[64:79], v[168:171], v[188:191], v[64:79]
    v_mfma_f32_32x32x16_bf16 v[80:95], v[172:175], v[188:191], v[80:95]
    v_mfma_f32_32x32x16_bf16 v[96:111], v[176:179], v[188:191], v[96:111]
    v_mfma_f32_32x32x16_bf16 v[112:127], v[180:183], v[188:191], v[112:127]
    v_mfma_f32_32x32x16_bf16 v[128:143], v[184:187], v[188:191], v[128:143]
    ds_read_b64_tr_b16 v[188:189], v44 offset:28672
    ds_read_b64_tr_b16 v[190:191], v44 offset:29696
    ds_read_b128 v[168:171], v43 offset:20480
    ds_read_b128 v[172:175], v43 offset:24576
    ds_read_b128 v[176:179], v43 offset:28672
    ds_read_b128 v[180:183], v43 offset:32768
    ds_read_b128 v[184:187], v43 offset:36864
    s_waitcnt lgkmcnt(7)
    v_mfma_f32_32x32x16_bf16 v[64:79], v[144:147], v[164:167], v[64:79]
    v_mfma_f32_32x32x16_bf16 v[80:95], v[148:151], v[164:167], v[80:95]
    v_mfma_f32_32x32x16_bf16 v[96:111], v[152:155], v[164:167], v[96:111]
    v_mfma_f32_32x32x16_bf16 v[112:127], v[156:159], v[164:167], v[112:127]
    v_mfma_f32_32x32x16_bf16 v[128:143], v[160:163], v[164:167], v[128:143]
    s_waitcnt lgkmcnt(0)
    v_mfma_f32_32x32x16_bf16 v[64:79], v[168:171], v[188:191], v[64:79]
    v_mfma_f32_32x32x16_bf16 v[80:95], v[172:175], v[188:191], v[80:95]
    v_mfma_f32_32x32x16_bf16 v[96:111], v[176:179], v[188:191], v[96:111]
    v_mfma_f32_32x32x16_bf16 v[112:127], v[180:183], v[188:191], v[112:127]
    v_mfma_f32_32x32x16_bf16 v[128:143], v[184:187], v[188:191], v[128:143]
    s_waitcnt vmcnt(9)
    s_barrier
    v_add_u32 v40, 40960, v40
    v_add_u32 v41, 40960, v41
    v_add_u32 v42, 40960, v42
    v_add_u32 v43, 40960, v43
    ds_read_b64_tr_b16 v[164:165], v44 offset:32768
    ds_read_b64_tr_b16 v[166:167], v44 offset:33792
    ds_read_b128 v[144:147], v40 offset:0
    ds_read_b128 v[148:151], v40 offset:4096
    ds_read_b128 v[152:155], v40 offset:8192
    ds_read_b128 v[156:159], v40 offset:12288
    ds_read_b128 v[160:163], v40 offset:16384
    ds_read_b64_tr_b16 v[188:189], v44 offset:36864
    ds_read_b64_tr_b16 v[190:191], v44 offset:37888
    ds_read_b128 v[168:171], v41 offset:0
    ds_read_b128 v[172:175], v41 offset:4096
    ds_read_b128 v[176:179], v41 offset:8192
    ds_read_b128 v[180:183], v41 offset:12288
    ds_read_b128 v[184:187], v41 offset:16384
    s_waitcnt lgkmcnt(7)
    v_mfma_f32_32x32x16_bf16 v[64:79], v[144:147], v[164:167], v[64:79]
    v_mfma_f32_32x32x16_bf16 v[80:95], v[148:151], v[164:167], v[80:95]
    v_mfma_f32_32x32x16_bf16 v[96:111], v[152:155], v[164:167], v[96:111]
    v_mfma_f32_32x32x16_bf16 v[112:127], v[156:159], v[164:167], v[112:127]
    v_mfma_f32_32x32x16_bf16 v[128:143], v[160:163], v[164:167], v[128:143]
    ds_read_b64_tr_b16 v[164:165], v44 offset:40960
    ds_read_b64_tr_b16 v[166:167], v44 offset:41984
    ds_read_b128 v[144:147], v42 offset:0
    ds_read_b128 v[148:151], v42 offset:4096
    ds_read_b128 v[152:155], v42 offset:8192
    ds_read_b128 v[156:159], v42 offset:12288
    ds_read_b128 v[160:163], v42 offset:16384
    s_waitcnt lgkmcnt(7)
    v_mfma_f32_32x32x16_bf16 v[64:79], v[168:171], v[188:191], v[64:79]
    v_mfma_f32_32x32x16_bf16 v[80:95], v[172:175], v[188:191], v[80:95]
    v_mfma_f32_32x32x16_bf16 v[96:111], v[176:179], v[188:191], v[96:111]
    v_mfma_f32_32x32x16_bf16 v[112:127], v[180:183], v[188:191], v[112:127]
    v_mfma_f32_32x32x16_bf16 v[128:143], v[184:187], v[188:191], v[128:143]
    ds_read_b64_tr_b16 v[188:189], v44 offset:45056
    ds_read_b64_tr_b16 v[190:191], v44 offset:46080
    ds_read_b128 v[168:171], v43 offset:0
    ds_read_b128 v[172:175], v43 offset:4096
    ds_read_b128 v[176:179], v43 offset:8192
    ds_read_b128 v[180:183], v43 offset:12288
    ds_read_b128 v[184:187], v43 offset:16384
    s_waitcnt lgkmcnt(7)
    v_mfma_f32_32x32x16_bf16 v[64:79], v[144:147], v[164:167], v[64:79]
    v_mfma_f32_32x32x16_bf16 v[80:95], v[148:151], v[164:167], v[80:95]
    v_mfma_f32_32x32x16_bf16 v[96:111], v[152:155], v[164:167], v[96:111]
    v_mfma_f32_32x32x16_bf16 v[112:127], v[156:159], v[164:167], v[112:127]
    v_mfma_f32_32x32x16_bf16 v[128:143], v[160:163], v[164:167], v[128:143]
    s_waitcnt lgkmcnt(0)
    v_mfma_f32_32x32x16_bf16 v[64:79], v[168:171], v[188:191], v[64:79]
    v_mfma_f32_32x32x16_bf16 v[80:95], v[172:175], v[188:191], v[80:95]
    v_mfma_f32_32x32x16_bf16 v[96:111], v[176:179], v[188:191], v[96:111]
    v_mfma_f32_32x32x16_bf16 v[112:127], v[180:183], v[188:191], v[112:127]
    v_mfma_f32_32x32x16_bf16 v[128:143], v[184:187], v[188:191], v[128:143]
    s_waitcnt vmcnt(0)
    s_barrier
    ds_read_b64_tr_b16 v[164:165], v44 offset:49152
    ds_read_b64_tr_b16 v[166:167], v44 offset:50176
    ds_read_b128 v[144:147], v40 offset:20480
    ds_read_b128 v[148:151], v40 offset:24576
    ds_read_b128 v[152:155], v40 offset:28672
    ds_read_b128 v[156:159], v40 offset:32768
    ds_read_b128 v[160:163], v40 offset:36864
    ds_read_b64_tr_b16 v[188:189], v44 offset:53248
    ds_read_b64_tr_b16 v[190:191], v44 offset:54272
    ds_read_b128 v[168:171], v41 offset:20480
    ds_read_b128 v[172:175], v41 offset:24576
    ds_read_b128 v[176:179], v41 offset:28672
    ds_read_b128 v[180:183], v41 offset:32768
    ds_read_b128 v[184:187], v41 offset:36864
    s_waitcnt lgkmcnt(7)
    v_mfma_f32_32x32x16_bf16 v[64:79], v[144:147], v[164:167], v[64:79]
    v_mfma_f32_32x32x16_bf16 v[80:95], v[148:151], v[164:167], v[80:95]
    v_mfma_f32_32x32x16_bf16 v[96:111], v[152:155], v[164:167], v[96:111]
    v_mfma_f32_32x32x16_bf16 v[112:127], v[156:159], v[164:167], v[112:127]
    v_mfma_f32_32x32x16_bf16 v[128:143], v[160:163], v[164:167], v[128:143]
    ds_read_b64_tr_b16 v[164:165], v44 offset:57344
    ds_read_b64_tr_b16 v[166:167], v44 offset:58368
    ds_read_b128 v[144:147], v42 offset:20480
    ds_read_b128 v[148:151], v42 offset:24576
    ds_read_b128 v[152:155], v42 offset:28672
    ds_read_b128 v[156:159], v42 offset:32768
    ds_read_b128 v[160:163], v42 offset:36864
    s_waitcnt lgkmcnt(7)
    v_mfma_f32_32x32x16_bf16 v[64:79], v[168:171], v[188:191], v[64:79]
    v_mfma_f32_32x32x16_bf16 v[80:95], v[172:175], v[188:191], v[80:95]
    v_mfma_f32_32x32x16_bf16 v[96:111], v[176:179], v[188:191], v[96:111]
    v_mfma_f32_32x32x16_bf16 v[112:127], v[180:183], v[188:191], v[112:127]
    v_mfma_f32_32x32x16_bf16 v[128:143], v[184:187], v[188:191], v[128:143]
    ds_read_b64_tr_b16 v[188:189], v44 offset:61440
    ds_read_b64_tr_b16 v[190:191], v44 offset:62464
    ds_read_b128 v[168:171], v43 offset:20480
    ds_read_b128 v[172:175], v43 offset:24576
    ds_read_b128 v[176:179], v43 offset:28672
    ds_read_b128 v[180:183], v43 offset:32768
    ds_read_b128 v[184:187], v43 offset:36864
    s_waitcnt lgkmcnt(7)
    v_mfma_f32_32x32x16_bf16 v[64:79], v[144:147], v[164:167], v[64:79]
    v_mfma_f32_32x32x16_bf16 v[80:95], v[148:151], v[164:167], v[80:95]
    v_mfma_f32_32x32x16_bf16 v[96:111], v[152:155], v[164:167], v[96:111]
    v_mfma_f32_32x32x16_bf16 v[112:127], v[156:159], v[164:167], v[112:127]
    v_mfma_f32_32x32x16_bf16 v[128:143], v[160:163], v[164:167], v[128:143]
    s_waitcnt lgkmcnt(0)
    v_mfma_f32_32x32x16_bf16 v[64:79], v[168:171], v[188:191], v[64:79]
    v_mfma_f32_32x32x16_bf16 v[80:95], v[172:175], v[188:191], v[80:95]
    v_mfma_f32_32x32x16_bf16 v[96:111], v[176:179], v[188:191], v[96:111]
    v_mfma_f32_32x32x16_bf16 v[112:127], v[180:183], v[188:191], v[112:127]
    v_mfma_f32_32x32x16_bf16 v[128:143], v[184:187], v[188:191], v[128:143]
    s_mov_b32 s38, 0xbfb8aa3b
    s_mov_b32 s39, 0xbfb8aa3b
    v_and_b32 v4, 31, v1
    v_lshrrev_b32 v5, 5, v1
    s_and_b32 s8, s6, 1
    s_lshl_b32 s8, s8, 7
    s_lshl_b32 s9, s3, 5
    s_add_u32 s8, s8, s9
    v_add_u32 v4, s8, v4
    v_lshlrev_b32 v4, 4, v4
    v_lshl_add_u32 v4, v5, 12, v4
    s_mul_i32 s8, s7, 81920
    s_add_u32 s8, s8, 5242880
    v_pk_mul_f32 v[64:65], v[64:65], s[38:39]
    v_pk_mul_f32 v[66:67], v[66:67], s[38:39]
    v_pk_mul_f32 v[68:69], v[68:69], s[38:39]
    v_pk_mul_f32 v[70:71], v[70:71], s[38:39]
    v_cvt_pk_bf16_f32 v144, v64, v65
    v_cvt_pk_bf16_f32 v145, v66, v67
    v_cvt_pk_bf16_f32 v146, v68, v69
    v_cvt_pk_bf16_f32 v147, v70, v71
    s_add_u32 s9, s8, 0
    buffer_store_dwordx4 v[144:147], v4, s[60:63], s9 offen sc0 sc1
    v_pk_mul_f32 v[72:73], v[72:73], s[38:39]
    v_pk_mul_f32 v[74:75], v[74:75], s[38:39]
    v_pk_mul_f32 v[76:77], v[76:77], s[38:39]
    v_pk_mul_f32 v[78:79], v[78:79], s[38:39]
    v_cvt_pk_bf16_f32 v148, v72, v73
    v_cvt_pk_bf16_f32 v149, v74, v75
    v_cvt_pk_bf16_f32 v150, v76, v77
    v_cvt_pk_bf16_f32 v151, v78, v79
    s_add_u32 s9, s8, 8192
    buffer_store_dwordx4 v[148:151], v4, s[60:63], s9 offen sc0 sc1
    v_pk_mul_f32 v[80:81], v[80:81], s[38:39]
    v_pk_mul_f32 v[82:83], v[82:83], s[38:39]
    v_pk_mul_f32 v[84:85], v[84:85], s[38:39]
    v_pk_mul_f32 v[86:87], v[86:87], s[38:39]
    v_cvt_pk_bf16_f32 v152, v80, v81
    v_cvt_pk_bf16_f32 v153, v82, v83
    v_cvt_pk_bf16_f32 v154, v84, v85
    v_cvt_pk_bf16_f32 v155, v86, v87
    s_add_u32 s9, s8, 16384
    buffer_store_dwordx4 v[152:155], v4, s[60:63], s9 offen sc0 sc1
    v_pk_mul_f32 v[88:89], v[88:89], s[38:39]
    v_pk_mul_f32 v[90:91], v[90:91], s[38:39]
    v_pk_mul_f32 v[92:93], v[92:93], s[38:39]
    v_pk_mul_f32 v[94:95], v[94:95], s[38:39]
    v_cvt_pk_bf16_f32 v156, v88, v89
    v_cvt_pk_bf16_f32 v157, v90, v91
    v_cvt_pk_bf16_f32 v158, v92, v93
    v_cvt_pk_bf16_f32 v159, v94, v95
    s_add_u32 s9, s8, 24576
    buffer_store_dwordx4 v[156:159], v4, s[60:63], s9 offen sc0 sc1
    v_pk_mul_f32 v[96:97], v[96:97], s[38:39]
    v_pk_mul_f32 v[98:99], v[98:99], s[38:39]
    v_pk_mul_f32 v[100:101], v[100:101], s[38:39]
    v_pk_mul_f32 v[102:103], v[102:103], s[38:39]
    v_cvt_pk_bf16_f32 v144, v96, v97
    v_cvt_pk_bf16_f32 v145, v98, v99
    v_cvt_pk_bf16_f32 v146, v100, v101
    v_cvt_pk_bf16_f32 v147, v102, v103
    s_add_u32 s9, s8, 32768
    buffer_store_dwordx4 v[144:147], v4, s[60:63], s9 offen sc0 sc1
    v_pk_mul_f32 v[104:105], v[104:105], s[38:39]
    v_pk_mul_f32 v[106:107], v[106:107], s[38:39]
    v_pk_mul_f32 v[108:109], v[108:109], s[38:39]
    v_pk_mul_f32 v[110:111], v[110:111], s[38:39]
    v_cvt_pk_bf16_f32 v148, v104, v105
    v_cvt_pk_bf16_f32 v149, v106, v107
    v_cvt_pk_bf16_f32 v150, v108, v109
    v_cvt_pk_bf16_f32 v151, v110, v111
    s_add_u32 s9, s8, 40960
    buffer_store_dwordx4 v[148:151], v4, s[60:63], s9 offen sc0 sc1
    v_pk_mul_f32 v[112:113], v[112:113], s[38:39]
    v_pk_mul_f32 v[114:115], v[114:115], s[38:39]
    v_pk_mul_f32 v[116:117], v[116:117], s[38:39]
    v_pk_mul_f32 v[118:119], v[118:119], s[38:39]
    v_cvt_pk_bf16_f32 v152, v112, v113
    v_cvt_pk_bf16_f32 v153, v114, v115
    v_cvt_pk_bf16_f32 v154, v116, v117
    v_cvt_pk_bf16_f32 v155, v118, v119
    s_add_u32 s9, s8, 49152
    buffer_store_dwordx4 v[152:155], v4, s[60:63], s9 offen sc0 sc1
    v_pk_mul_f32 v[120:121], v[120:121], s[38:39]
    v_pk_mul_f32 v[122:123], v[122:123], s[38:39]
    v_pk_mul_f32 v[124:125], v[124:125], s[38:39]
    v_pk_mul_f32 v[126:127], v[126:127], s[38:39]
    v_cvt_pk_bf16_f32 v156, v120, v121
    v_cvt_pk_bf16_f32 v157, v122, v123
    v_cvt_pk_bf16_f32 v158, v124, v125
    v_cvt_pk_bf16_f32 v159, v126, v127
    s_add_u32 s9, s8, 57344
    buffer_store_dwordx4 v[156:159], v4, s[60:63], s9 offen sc0 sc1
    v_pk_mul_f32 v[128:129], v[128:129], s[38:39]
    v_pk_mul_f32 v[130:131], v[130:131], s[38:39]
    v_pk_mul_f32 v[132:133], v[132:133], s[38:39]
    v_pk_mul_f32 v[134:135], v[134:135], s[38:39]
    v_cvt_pk_bf16_f32 v144, v128, v129
    v_cvt_pk_bf16_f32 v145, v130, v131
    v_cvt_pk_bf16_f32 v146, v132, v133
    v_cvt_pk_bf16_f32 v147, v134, v135
    s_add_u32 s9, s8, 65536
    buffer_store_dwordx4 v[144:147], v4, s[60:63], s9 offen sc0 sc1
    v_pk_mul_f32 v[136:137], v[136:137], s[38:39]
    v_pk_mul_f32 v[138:139], v[138:139], s[38:39]
    v_pk_mul_f32 v[140:141], v[140:141], s[38:39]
    v_pk_mul_f32 v[142:143], v[142:143], s[38:39]
    v_cvt_pk_bf16_f32 v148, v136, v137
    v_cvt_pk_bf16_f32 v149, v138, v139
    v_cvt_pk_bf16_f32 v150, v140, v141
    v_cvt_pk_bf16_f32 v151, v142, v143
    s_add_u32 s9, s8, 73728
    buffer_store_dwordx4 v[148:151], v4, s[60:63], s9 offen sc0 sc1
    s_branch k1_part
k1_gemmB:
    ds_read_b64_tr_b16 v[164:165], v44 offset:0
    ds_read_b64_tr_b16 v[166:167], v44 offset:1024
    ds_read_b128 v[144:147], v40 offset:0
    ds_read_b128 v[148:151], v40 offset:4096
    ds_read_b128 v[152:155], v40 offset:8192
    ds_read_b128 v[156:159], v40 offset:12288
    ds_read_b128 v[160:163], v40 offset:16384
    ds_read_b64_tr_b16 v[188:189], v44 offset:4096
    ds_read_b64_tr_b16 v[190:191], v44 offset:5120
    ds_read_b128 v[168:171], v41 offset:0
    ds_read_b128 v[172:175], v41 offset:4096
    ds_read_b128 v[176:179], v41 offset:8192
    ds_read_b128 v[180:183], v41 offset:12288
    ds_read_b128 v[184:187], v41 offset:16384
    s_waitcnt lgkmcnt(7)
    v_mfma_f32_32x32x16_bf16 v[64:79], v[164:167], v[144:147], 0
    v_mfma_f32_32x32x16_bf16 v[80:95], v[164:167], v[148:151], 0
    v_mfma_f32_32x32x16_bf16 v[96:111], v[164:167], v[152:155], 0
    v_mfma_f32_32x32x16_bf16 v[112:127], v[164:167], v[156:159], 0
    v_mfma_f32_32x32x16_bf16 v[128:143], v[164:167], v[160:163], 0
    ds_read_b64_tr_b16 v[164:165], v44 offset:8192
    ds_read_b64_tr_b16 v[166:167], v44 offset:9216
    ds_read_b128 v[144:147], v42 offset:0
    ds_read_b128 v[148:151], v42 offset:4096
    ds_read_b128 v[152:155], v42 offset:8192
    ds_read_b128 v[156:159], v42 offset:12288
    ds_read_b128 v[160:163], v42 offset:16384
    s_waitcnt lgkmcnt(7)
    v_mfma_f32_32x32x16_bf16 v[64:79], v[188:191], v[168:171], v[64:79]
    v_mfma_f32_32x32x16_bf16 v[80:95], v[188:191], v[172:175], v[80:95]
    v_mfma_f32_32x32x16_bf16 v[96:111], v[188:191], v[176:179], v[96:111]
    v_mfma_f32_32x32x16_bf16 v[112:127], v[188:191], v[180:183], v[112:127]
    v_mfma_f32_32x32x16_bf16 v[128:143], v[188:191], v[184:187], v[128:143]
    ds_read_b64_tr_b16 v[188:189], v44 offset:12288
    ds_read_b64_tr_b16 v[190:191], v44 offset:13312
    ds_read_b128 v[168:171], v43 offset:0
    ds_read_b128 v[172:175], v43 offset:4096
    ds_read_b128 v[176:179], v43 offset:8192
    ds_read_b128 v[180:183], v43 offset:12288
    ds_read_b128 v[184:187], v43 offset:16384
    s_waitcnt lgkmcnt(7)
    v_mfma_f32_32x32x16_bf16 v[64:79], v[164:167], v[144:147], v[64:79]
    v_mfma_f32_32x32x16_bf16 v[80:95], v[164:167], v[148:151], v[80:95]
    v_mfma_f32_32x32x16_bf16 v[96:111], v[164:167], v[152:155], v[96:111]
    v_mfma_f32_32x32x16_bf16 v[112:127], v[164:167], v[156:159], v[112:127]
    v_mfma_f32_32x32x16_bf16 v[128:143], v[164:167], v[160:163], v[128:143]
    s_waitcnt lgkmcnt(0)
    v_mfma_f32_32x32x16_bf16 v[64:79], v[188:191], v[168:171], v[64:79]
    v_mfma_f32_32x32x16_bf16 v[80:95], v[188:191], v[172:175], v[80:95]
    v_mfma_f32_32x32x16_bf16 v[96:111], v[188:191], v[176:179], v[96:111]
    v_mfma_f32_32x32x16_bf16 v[112:127], v[188:191], v[180:183], v[112:127]
    v_mfma_f32_32x32x16_bf16 v[128:143], v[188:191], v[184:187], v[128:143]
    s_waitcnt vmcnt(18)
    s_barrier
    ds_read_b64_tr_b16 v[164:165], v44 offset:16384
    ds_read_b64_tr_b16 v[166:167], v44 offset:17408
    ds_read_b128 v[144:147], v40 offset:20480
    ds_read_b128 v[148:151], v40 offset:24576
    ds_read_b128 v[152:155], v40 offset:28672
    ds_read_b128 v[156:159], v40 offset:32768
    ds_read_b128 v[160:163], v40 offset:36864
    ds_read_b64_tr_b16 v[188:189], v44 offset:20480
    ds_read_b64_tr_b16 v[190:191], v44 offset:21504
    ds_read_b128 v[168:171], v41 offset:20480
    ds_read_b128 v[172:175], v41 offset:24576
    ds_read_b128 v[176:179], v41 offset:28672
    ds_read_b128 v[180:183], v41 offset:32768
    ds_read_b128 v[184:187], v41 offset:36864
    s_waitcnt lgkmcnt(7)
    v_mfma_f32_32x32x16_bf16 v[64:79], v[164:167], v[144:147], v[64:79]
    v_mfma_f32_32x32x16_bf16 v[80:95], v[164:167], v[148:151], v[80:95]
    v_mfma_f32_32x32x16_bf16 v[96:111], v[164:167], v[152:155], v[96:111]
    v_mfma_f32_32x32x16_bf16 v[112:127], v[164:167], v[156:159], v[112:127]
    v_mfma_f32_32x32x16_bf16 v[128:143], v[164:167], v[160:163], v[128:143]
    ds_read_b64_tr_b16 v[164:165], v44 offset:24576
    ds_read_b64_tr_b16 v[166:167], v44 offset:25600
    ds_read_b128 v[144:147], v42 offset:20480
    ds_read_b128 v[148:151], v42 offset:24576
    ds_read_b128 v[152:155], v42 offset:28672
    ds_read_b128 v[156:159], v42 offset:32768
    ds_read_b128 v[160:163], v42 offset:36864
    s_waitcnt lgkmcnt(7)
    v_mfma_f32_32x32x16_bf16 v[64:79], v[188:191], v[168:171], v[64:79]
    v_mfma_f32_32x32x16_bf16 v[80:95], v[188:191], v[172:175], v[80:95]
    v_mfma_f32_32x32x16_bf16 v[96:111], v[188:191], v[176:179], v[96:111]
    v_mfma_f32_32x32x16_bf16 v[112:127], v[188:191], v[180:183], v[112:127]
    v_mfma_f32_32x32x16_bf16 v[128:143], v[188:191], v[184:187], v[128:143]
    ds_read_b64_tr_b16 v[188:189], v44 offset:28672
    ds_read_b64_tr_b16 v[190:191], v44 offset:29696
    ds_read_b128 v[168:171], v43 offset:20480
    ds_read_b128 v[172:175], v43 offset:24576
    ds_read_b128 v[176:179], v43 offset:28672
    ds_read_b128 v[180:183], v43 offset:32768
    ds_read_b128 v[184:187], v43 offset:36864
    s_waitcnt lgkmcnt(7)
    v_mfma_f32_32x32x16_bf16 v[64:79], v[164:167], v[144:147], v[64:79]
    v_mfma_f32_32x32x16_bf16 v[80:95], v[164:167], v[148:151], v[80:95]
    v_mfma_f32_32x32x16_bf16 v[96:111], v[164:167], v[152:155], v[96:111]
    v_mfma_f32_32x32x16_bf16 v[112:127], v[164:167], v[156:159], v[112:127]
    v_mfma_f32_32x32x16_bf16 v[128:143], v[164:167], v[160:163], v[128:143]
    s_waitcnt lgkmcnt(0)
    v_mfma_f32_32x32x16_bf16 v[64:79], v[188:191], v[168:171], v[64:79]
    v_mfma_f32_32x32x16_bf16 v[80:95], v[188:191], v[172:175], v[80:95]
    v_mfma_f32_32x32x16_bf16 v[96:111], v[188:191], v[176:179], v[96:111]
    v_mfma_f32_32x32x16_bf16 v[112:127], v[188:191], v[180:183], v[112:127]
    v_mfma_f32_32x32x16_bf16 v[128:143], v[188:191], v[184:187], v[128:143]
    s_waitcnt vmcnt(9)
    s_barrier
    v_add_u32 v40, 40960, v40
    v_add_u32 v41, 40960, v41
    v_add_u32 v42, 40960, v42
    v_add_u32 v43, 40960, v43
    ds_read_b64_tr_b16 v[164:165], v44 offset:32768
    ds_read_b64_tr_b16 v[166:167], v44 offset:33792
    ds_read_b128 v[144:147], v40 offset:0
    ds_read_b128 v[148:151], v40 offset:4096
    ds_read_b128 v[152:155], v40 offset:8192
    ds_read_b128 v[156:159], v40 offset:12288
    ds_read_b128 v[160:163], v40 offset:16384
    ds_read_b64_tr_b16 v[188:189], v44 offset:36864
    ds_read_b64_tr_b16 v[190:191], v44 offset:37888
    ds_read_b128 v[168:171], v41 offset:0
    ds_read_b128 v[172:175], v41 offset:4096
    ds_read_b128 v[176:179], v41 offset:8192
    ds_read_b128 v[180:183], v41 offset:12288
    ds_read_b128 v[184:187], v41 offset:16384
    s_waitcnt lgkmcnt(7)
    v_mfma_f32_32x32x16_bf16 v[64:79], v[164:167], v[144:147], v[64:79]
    v_mfma_f32_32x32x16_bf16 v[80:95], v[164:167], v[148:151], v[80:95]
    v_mfma_f32_32x32x16_bf16 v[96:111], v[164:167], v[152:155], v[96:111]
    v_mfma_f32_32x32x16_bf16 v[112:127], v[164:167], v[156:159], v[112:127]
    v_mfma_f32_32x32x16_bf16 v[128:143], v[164:167], v[160:163], v[128:143]
    ds_read_b64_tr_b16 v[164:165], v44 offset:40960
    ds_read_b64_tr_b16 v[166:167], v44 offset:41984
    ds_read_b128 v[144:147], v42 offset:0
    ds_read_b128 v[148:151], v42 offset:4096
    ds_read_b128 v[152:155], v42 offset:8192
    ds_read_b128 v[156:159], v42 offset:12288
    ds_read_b128 v[160:163], v42 offset:16384
    s_waitcnt lgkmcnt(7)
    v_mfma_f32_32x32x16_bf16 v[64:79], v[188:191], v[168:171], v[64:79]
    v_mfma_f32_32x32x16_bf16 v[80:95], v[188:191], v[172:175], v[80:95]
    v_mfma_f32_32x32x16_bf16 v[96:111], v[188:191], v[176:179], v[96:111]
    v_mfma_f32_32x32x16_bf16 v[112:127], v[188:191], v[180:183], v[112:127]
    v_mfma_f32_32x32x16_bf16 v[128:143], v[188:191], v[184:187], v[128:143]
    ds_read_b64_tr_b16 v[188:189], v44 offset:45056
    ds_read_b64_tr_b16 v[190:191], v44 offset:46080
    ds_read_b128 v[168:171], v43 offset:0
    ds_read_b128 v[172:175], v43 offset:4096
    ds_read_b128 v[176:179], v43 offset:8192
    ds_read_b128 v[180:183], v43 offset:12288
    ds_read_b128 v[184:187], v43 offset:16384
    s_waitcnt lgkmcnt(7)
    v_mfma_f32_32x32x16_bf16 v[64:79], v[164:167], v[144:147], v[64:79]
    v_mfma_f32_32x32x16_bf16 v[80:95], v[164:167], v[148:151], v[80:95]
    v_mfma_f32_32x32x16_bf16 v[96:111], v[164:167], v[152:155], v[96:111]
    v_mfma_f32_32x32x16_bf16 v[112:127], v[164:167], v[156:159], v[112:127]
    v_mfma_f32_32x32x16_bf16 v[128:143], v[164:167], v[160:163], v[128:143]
    s_waitcnt lgkmcnt(0)
    v_mfma_f32_32x32x16_bf16 v[64:79], v[188:191], v[168:171], v[64:79]
    v_mfma_f32_32x32x16_bf16 v[80:95], v[188:191], v[172:175], v[80:95]
    v_mfma_f32_32x32x16_bf16 v[96:111], v[188:191], v[176:179], v[96:111]
    v_mfma_f32_32x32x16_bf16 v[112:127], v[188:191], v[180:183], v[112:127]
    v_mfma_f32_32x32x16_bf16 v[128:143], v[188:191], v[184:187], v[128:143]
    s_waitcnt vmcnt(0)
    s_barrier
    ds_read_b64_tr_b16 v[164:165], v44 offset:49152
    ds_read_b64_tr_b16 v[166:167], v44 offset:50176
    ds_read_b128 v[144:147], v40 offset:20480
    ds_read_b128 v[148:151], v40 offset:24576
    ds_read_b128 v[152:155], v40 offset:28672
    ds_read_b128 v[156:159], v40 offset:32768
    ds_read_b128 v[160:163], v40 offset:36864
    ds_read_b64_tr_b16 v[188:189], v44 offset:53248
    ds_read_b64_tr_b16 v[190:191], v44 offset:54272
    ds_read_b128 v[168:171], v41 offset:20480
    ds_read_b128 v[172:175], v41 offset:24576
    ds_read_b128 v[176:179], v41 offset:28672
    ds_read_b128 v[180:183], v41 offset:32768
    ds_read_b128 v[184:187], v41 offset:36864
    s_waitcnt lgkmcnt(7)
    v_mfma_f32_32x32x16_bf16 v[64:79], v[164:167], v[144:147], v[64:79]
    v_mfma_f32_32x32x16_bf16 v[80:95], v[164:167], v[148:151], v[80:95]
    v_mfma_f32_32x32x16_bf16 v[96:111], v[164:167], v[152:155], v[96:111]
    v_mfma_f32_32x32x16_bf16 v[112:127], v[164:167], v[156:159], v[112:127]
    v_mfma_f32_32x32x16_bf16 v[128:143], v[164:167], v[160:163], v[128:143]
    ds_read_b64_tr_b16 v[164:165], v44 offset:57344
    ds_read_b64_tr_b16 v[166:167], v44 offset:58368
    ds_read_b128 v[144:147], v42 offset:20480
    ds_read_b128 v[148:151], v42 offset:24576
    ds_read_b128 v[152:155], v42 offset:28672
    ds_read_b128 v[156:159], v42 offset:32768
    ds_read_b128 v[160:163], v42 offset:36864
    s_waitcnt lgkmcnt(7)
    v_mfma_f32_32x32x16_bf16 v[64:79], v[188:191], v[168:171], v[64:79]
    v_mfma_f32_32x32x16_bf16 v[80:95], v[188:191], v[172:175], v[80:95]
    v_mfma_f32_32x32x16_bf16 v[96:111], v[188:191], v[176:179], v[96:111]
    v_mfma_f32_32x32x16_bf16 v[112:127], v[188:191], v[180:183], v[112:127]
    v_mfma_f32_32x32x16_bf16 v[128:143], v[188:191], v[184:187], v[128:143]
    ds_read_b64_tr_b16 v[188:189], v44 offset:61440
    ds_read_b64_tr_b16 v[190:191], v44 offset:62464
    ds_read_b128 v[168:171], v43 offset:20480
    ds_read_b128 v[172:175], v43 offset:24576
    ds_read_b128 v[176:179], v43 offset:28672
    ds_read_b128 v[180:183], v43 offset:32768
    ds_read_b128 v[184:187], v43 offset:36864
    s_waitcnt lgkmcnt(7)
    v_mfma_f32_32x32x16_bf16 v[64:79], v[164:167], v[144:147], v[64:79]
    v_mfma_f32_32x32x16_bf16 v[80:95], v[164:167], v[148:151], v[80:95]
    v_mfma_f32_32x32x16_bf16 v[96:111], v[164:167], v[152:155], v[96:111]
    v_mfma_f32_32x32x16_bf16 v[112:127], v[164:167], v[156:159], v[112:127]
    v_mfma_f32_32x32x16_bf16 v[128:143], v[164:167], v[160:163], v[128:143]
    s_waitcnt lgkmcnt(0)
    v_mfma_f32_32x32x16_bf16 v[64:79], v[188:191], v[168:171], v[64:79]
    v_mfma_f32_32x32x16_bf16 v[80:95], v[188:191], v[172:175], v[80:95]
    v_mfma_f32_32x32x16_bf16 v[96:111], v[188:191], v[176:179], v[96:111]
    v_mfma_f32_32x32x16_bf16 v[112:127], v[188:191], v[180:183], v[112:127]
    v_mfma_f32_32x32x16_bf16 v[128:143], v[188:191], v[184:187], v[128:143]
    s_mov_b32 s38, 0xbfb8aa3b
    s_mov_b32 s39, 0xbfb8aa3b
    v_and_b32 v4, 31, v1
    v_lshrrev_b32 v5, 5, v1
    v_and_b32 v6, 15, v1
    s_lshl_b32 s8, s3, 2
    v_xor_b32 v6, s8, v6
    v_lshlrev_b32 v6, 4, v6
    v_lshl_add_u32 v6, v4, 8, v6
    v_lshl_add_u32 v6, v5, 3, v6
    v_xor_b32 v7, 16, v6
    v_xor_b32 v8, 32, v6
    v_xor_b32 v9, 48, v6
    v_pk_mul_f32 v[64:65], v[64:65], s[38:39]
    v_pk_mul_f32 v[66:67], v[66:67], s[38:39]
    v_cvt_pk_bf16_f32 v144, v64, v65
    v_cvt_pk_bf16_f32 v145, v66, v67
    ds_write_b64 v6, v[144:145] offset:0
    v_pk_mul_f32 v[68:69], v[68:69], s[38:39]
    v_pk_mul_f32 v[70:71], v[70:71], s[38:39]
    v_cvt_pk_bf16_f32 v146, v68, v69
    v_cvt_pk_bf16_f32 v147, v70, v71
    ds_write_b64 v7, v[146:147] offset:0
    v_pk_mul_f32 v[72:73], v[72:73], s[38:39]
    v_pk_mul_f32 v[74:75], v[74:75], s[38:39]
    v_cvt_pk_bf16_f32 v148, v72, v73
    v_cvt_pk_bf16_f32 v149, v74, v75
    ds_write_b64 v8, v[148:149] offset:0
    v_pk_mul_f32 v[76:77], v[76:77], s[38:39]
    v_pk_mul_f32 v[78:79], v[78:79], s[38:39]
    v_cvt_pk_bf16_f32 v150, v76, v77
    v_cvt_pk_bf16_f32 v151, v78, v79
    ds_write_b64 v9, v[150:151] offset:0
    v_pk_mul_f32 v[80:81], v[80:81], s[38:39]
    v_pk_mul_f32 v[82:83], v[82:83], s[38:39]
    v_cvt_pk_bf16_f32 v152, v80, v81
    v_cvt_pk_bf16_f32 v153, v82, v83
    ds_write_b64 v6, v[152:153] offset:8192
    v_pk_mul_f32 v[84:85], v[84:85], s[38:39]
    v_pk_mul_f32 v[86:87], v[86:87], s[38:39]
    v_cvt_pk_bf16_f32 v154, v84, v85
    v_cvt_pk_bf16_f32 v155, v86, v87
    ds_write_b64 v7, v[154:155] offset:8192
    v_pk_mul_f32 v[88:89], v[88:89], s[38:39]
    v_pk_mul_f32 v[90:91], v[90:91], s[38:39]
    v_cvt_pk_bf16_f32 v156, v88, v89
    v_cvt_pk_bf16_f32 v157, v90, v91
    ds_write_b64 v8, v[156:157] offset:8192
    v_pk_mul_f32 v[92:93], v[92:93], s[38:39]
    v_pk_mul_f32 v[94:95], v[94:95], s[38:39]
    v_cvt_pk_bf16_f32 v158, v92, v93
    v_cvt_pk_bf16_f32 v159, v94, v95
    ds_write_b64 v9, v[158:159] offset:8192
    v_pk_mul_f32 v[96:97], v[96:97], s[38:39]
    v_pk_mul_f32 v[98:99], v[98:99], s[38:39]
    v_cvt_pk_bf16_f32 v144, v96, v97
    v_cvt_pk_bf16_f32 v145, v98, v99
    ds_write_b64 v6, v[144:145] offset:16384
    v_pk_mul_f32 v[100:101], v[100:101], s[38:39]
    v_pk_mul_f32 v[102:103], v[102:103], s[38:39]
    v_cvt_pk_bf16_f32 v146, v100, v101
    v_cvt_pk_bf16_f32 v147, v102, v103
    ds_write_b64 v7, v[146:147] offset:16384
    v_pk_mul_f32 v[104:105], v[104:105], s[38:39]
    v_pk_mul_f32 v[106:107], v[106:107], s[38:39]
    v_cvt_pk_bf16_f32 v148, v104, v105
    v_cvt_pk_bf16_f32 v149, v106, v107
    ds_write_b64 v8, v[148:149] offset:16384
    v_pk_mul_f32 v[108:109], v[108:109], s[38:39]
    v_pk_mul_f32 v[110:111], v[110:111], s[38:39]
    v_cvt_pk_bf16_f32 v150, v108, v109
    v_cvt_pk_bf16_f32 v151, v110, v111
    ds_write_b64 v9, v[150:151] offset:16384
    v_pk_mul_f32 v[112:113], v[112:113], s[38:39]
    v_pk_mul_f32 v[114:115], v[114:115], s[38:39]
    v_cvt_pk_bf16_f32 v152, v112, v113
    v_cvt_pk_bf16_f32 v153, v114, v115
    ds_write_b64 v6, v[152:153] offset:24576
    v_pk_mul_f32 v[116:117], v[116:117], s[38:39]
    v_pk_mul_f32 v[118:119], v[118:119], s[38:39]
    v_cvt_pk_bf16_f32 v154, v116, v117
    v_cvt_pk_bf16_f32 v155, v118, v119
    ds_write_b64 v7, v[154:155] offset:24576
    v_pk_mul_f32 v[120:121], v[120:121], s[38:39]
    v_pk_mul_f32 v[122:123], v[122:123], s[38:39]
    v_cvt_pk_bf16_f32 v156, v120, v121
    v_cvt_pk_bf16_f32 v157, v122, v123
    ds_write_b64 v8, v[156:157] offset:24576
    v_pk_mul_f32 v[124:125], v[124:125], s[38:39]
    v_pk_mul_f32 v[126:127], v[126:127], s[38:39]
    v_cvt_pk_bf16_f32 v158, v124, v125
    v_cvt_pk_bf16_f32 v159, v126, v127
    ds_write_b64 v9, v[158:159] offset:24576
    v_pk_mul_f32 v[128:129], v[128:129], s[38:39]
    v_pk_mul_f32 v[130:131], v[130:131], s[38:39]
    v_cvt_pk_bf16_f32 v144, v128, v129
    v_cvt_pk_bf16_f32 v145, v130, v131
    ds_write_b64 v6, v[144:145] offset:32768
    v_pk_mul_f32 v[132:133], v[132:133], s[38:39]
    v_pk_mul_f32 v[134:135], v[134:135], s[38:39]
    v_cvt_pk_bf16_f32 v146, v132, v133
    v_cvt_pk_bf16_f32 v147, v134, v135
    ds_write_b64 v7, v[146:147] offset:32768
    v_pk_mul_f32 v[136:137], v[136:137], s[38:39]
    v_pk_mul_f32 v[138:139], v[138:139], s[38:39]
    v_cvt_pk_bf16_f32 v148, v136, v137
    v_cvt_pk_bf16_f32 v149, v138, v139
    ds_write_b64 v8, v[148:149] offset:32768
    v_pk_mul_f32 v[140:141], v[140:141], s[38:39]
    v_pk_mul_f32 v[142:143], v[142:143], s[38:39]
    v_cvt_pk_bf16_f32 v150, v140, v141
    v_cvt_pk_bf16_f32 v151, v142, v143
    ds_write_b64 v9, v[150:151] offset:32768
    s_waitcnt lgkmcnt(0)
    s_barrier
    v_lshlrev_b32 v4, 4, v0
    v_lshrrev_b32 v5, 4, v0
    v_and_b32 v6, 15, v0
    v_xor_b32 v6, v6, v5
    v_lshlrev_b32 v6, 4, v6
    v_lshl_add_u32 v6, v5, 9, v6
    s_mul_i32 s8, s7, 81920
    s_and_b32 s9, s6, 1
    s_lshl_b32 s9, s9, 8
    s_add_u32 s8, s8, s9
    ds_read_b128 v[64:67], v4 offset:0
    ds_read_b128 v[68:71], v4 offset:4096
    ds_read_b128 v[72:75], v4 offset:8192
    ds_read_b128 v[76:79], v4 offset:12288
    ds_read_b128 v[80:83], v4 offset:16384
    ds_read_b128 v[84:87], v4 offset:20480
    ds_read_b128 v[88:91], v4 offset:24576
    ds_read_b128 v[92:95], v4 offset:28672
    ds_read_b128 v[96:99], v4 offset:32768
    ds_read_b128 v[100:103], v4 offset:36864
    s_waitcnt lgkmcnt(9)
    s_add_u32 s9, s8, 0
    buffer_store_dwordx4 v[64:67], v6, s[64:67], s9 offen sc0 sc1
    s_waitcnt lgkmcnt(8)
    s_add_u32 s9, s8, 8192
    buffer_store_dwordx4 v[68:71], v6, s[64:67], s9 offen sc0 sc1
    s_waitcnt lgkmcnt(7)
    s_add_u32 s9, s8, 16384
    buffer_store_dwordx4 v[72:75], v6, s[64:67], s9 offen sc0 sc1
    s_waitcnt lgkmcnt(6)
    s_add_u32 s9, s8, 24576
    buffer_store_dwordx4 v[76:79], v6, s[64:67], s9 offen sc0 sc1
    s_waitcnt lgkmcnt(5)
    s_add_u32 s9, s8, 32768
    buffer_store_dwordx4 v[80:83], v6, s[64:67], s9 offen sc0 sc1
    s_waitcnt lgkmcnt(4)
    s_add_u32 s9, s8, 40960
    buffer_store_dwordx4 v[84:87], v6, s[64:67], s9 offen sc0 sc1
    s_waitcnt lgkmcnt(3)
    s_add_u32 s9, s8, 49152
    buffer_store_dwordx4 v[88:91], v6, s[64:67], s9 offen sc0 sc1
    s_waitcnt lgkmcnt(2)
    s_add_u32 s9, s8, 57344
    buffer_store_dwordx4 v[92:95], v6, s[64:67], s9 offen sc0 sc1
    s_waitcnt lgkmcnt(1)
    s_add_u32 s9, s8, 65536
    buffer_store_dwordx4 v[96:99], v6, s[64:67], s9 offen sc0 sc1
    s_waitcnt lgkmcnt(0)
    s_add_u32 s9, s8, 73728
    buffer_store_dwordx4 v[100:103], v6, s[64:67], s9 offen sc0 sc1
k1_part:
    s_cmp_ge_u32 s2, 250
    s_cbranch_scc1 k1_nopart
    s_cmp_ge_u32 s7, 63
    s_cbranch_scc1 k1_pw0
    s_waitcnt vmcnt(36)
    s_branch k1_pw1
k1_pw0:
    s_waitcnt vmcnt(0)
k1_pw1:
    v_mov_b32 v8, 1
    v_mul_u32_u24 v46, 52429, v10
    v_lshrrev_b32 v46, 21, v46
    v_mul_u32_u24 v5, 40, v46
    v_sub_u32 v5, v10, v5
    v_lshl_or_b32 v50, v5, 14, v13
    v_add_u32 v7, 0, v0
    v_lshl_or_b32 v50, v7, 20, v50
    v_lshlrev_b32 v54, 6, v46
    v_add_u32 v54, 147456, v54
    ds_add_rtn_u32 v58, v54, v8
    v_mul_u32_u24 v47, 52429, v11
    v_lshrrev_b32 v47, 21, v47
    v_mul_u32_u24 v5, 40, v47
    v_sub_u32 v5, v11, v5
    v_lshl_or_b32 v51, v5, 14, v14
    v_add_u32 v7, 256, v0
    v_lshl_or_b32 v51, v7, 20, v51
    v_lshlrev_b32 v55, 6, v47
    v_add_u32 v55, 147456, v55
    ds_add_rtn_u32 v59, v55, v8
    v_mul_u32_u24 v48, 52429, v12
    v_lshrrev_b32 v48, 21, v48
    v_mul_u32_u24 v5, 40, v48
    v_sub_u32 v5, v12, v5
    v_lshl_or_b32 v52, v5, 14, v15
    v_add_u32 v7, 512, v0
    v_lshl_or_b32 v52, v7, 20, v52
    v_lshlrev_b32 v56, 6, v48
    v_add_u32 v56, 147456, v56
    v_cmp_gt_u32 vcc, 128, v0
    s_nop 0
    s_mov_b64 s[38:39], vcc
    s_mov_b64 exec, vcc
    ds_add_rtn_u32 v60, v56, v8
    s_mov_b64 exec, -1
    s_waitcnt lgkmcnt(0)
    v_cmp_gt_u32 vcc, 15, v58
    v_lshl_add_u32 v7, v58, 2, v54
    s_and_saveexec_b64 s[14:15], vcc
    ds_write_b32 v7, v50 offset:4
    s_andn2_b64 exec, s[14:15], exec
    s_cbranch_execz k1_noovf0
    v_mov_b32 v7, 163456
    ds_add_rtn_u32 v9, v7, v8
    s_waitcnt lgkmcnt(0)
    v_mov_b32 v6, v50
    v_mov_b32 v7, v46
    s_mul_i32 s12, s2, 5120
    s_add_u32 s12, s12, 14680064
    v_lshlrev_b32 v9, 3, v9
    buffer_store_dwordx2 v[6:7], v9, s[60:63], s12 offen sc0 sc1
k1_noovf0:
    s_mov_b64 exec, s[14:15]
    v_cmp_gt_u32 vcc, 15, v59
    v_lshl_add_u32 v7, v59, 2, v55
    s_and_saveexec_b64 s[14:15], vcc
    ds_write_b32 v7, v51 offset:4
    s_andn2_b64 exec, s[14:15], exec
    s_cbranch_execz k1_noovf1
    v_mov_b32 v7, 163456
    ds_add_rtn_u32 v9, v7, v8
    s_waitcnt lgkmcnt(0)
    v_mov_b32 v6, v51
    v_mov_b32 v7, v47
    s_mul_i32 s12, s2, 5120
    s_add_u32 s12, s12, 14680064
    v_lshlrev_b32 v9, 3, v9
    buffer_store_dwordx2 v[6:7], v9, s[60:63], s12 offen sc0 sc1
k1_noovf1:
    s_mov_b64 exec, s[14:15]
    s_mov_b64 exec, s[38:39]
    v_cmp_gt_u32 vcc, 15, v60
    v_lshl_add_u32 v7, v60, 2, v56
    s_and_saveexec_b64 s[14:15], vcc
    ds_write_b32 v7, v52 offset:4
    s_andn2_b64 exec, s[14:15], exec
    s_cbranch_execz k1_noovf2
    v_mov_b32 v7, 163456
    ds_add_rtn_u32 v9, v7, v8
    s_waitcnt lgkmcnt(0)
    v_mov_b32 v6, v52
    v_mov_b32 v7, v48
    s_mul_i32 s12, s2, 5120
    s_add_u32 s12, s12, 14680064
    v_lshlrev_b32 v9, 3, v9
    buffer_store_dwordx2 v[6:7], v9, s[60:63], s12 offen sc0 sc1
k1_noovf2:
    s_mov_b64 exec, s[14:15]
    s_mov_b64 exec, -1
k1_nopart:
    s_waitcnt lgkmcnt(0)
    s_barrier
    s_cmp_ge_u32 s2, 250
    s_cbranch_scc1 k1_noimg
    v_lshlrev_b32 v4, 4, v0
    v_add_u32 v4, 147456, v4
    ds_read_b128 v[16:19], v4 offset:0
    ds_read_b128 v[20:23], v4 offset:4096
    ds_read_b128 v[24:27], v4 offset:8192
    ds_read_b128 v[28:31], v4 offset:12288
    v_mov_b32 v6, 163456
    ds_read_b32 v8, v6
    v_lshrrev_b32 v5, 2, v0
    v_mul_u32_u24 v5, 16000, v5
    v_and_b32 v6, 3, v0
    v_lshl_add_u32 v5, v6, 4, v5
    s_lshl_b32 s38, s2, 6
    s_add_u32 s38, s38, 10485760
    s_mov_b32 s39, 232
    s_waitcnt lgkmcnt(0)
    v_and_b32 v6, 3, v0
    v_lshlrev_b32 v6, 2, v6
    v_mov_b32_dpp v7, v16 quad_perm:[0,0,0,0] row_mask:0xf bank_mask:0xf
    v_cmp_ge_u32 vcc, v6, v6
    s_nop 0
    s_and_saveexec_b64 s[14:15], vcc
    buffer_store_dwordx4 v[16:19], v5, s[60:63], s38 offen sc0 sc1
    s_mov_b64 exec, s[14:15]
    v_add_u32 v5, 1024000, v5
    v_mov_b32_dpp v7, v20 quad_perm:[0,0,0,0] row_mask:0xf bank_mask:0xf
    v_cmp_ge_u32 vcc, v6, v6
    s_nop 0
    s_and_saveexec_b64 s[14:15], vcc
    buffer_store_dwordx4 v[20:23], v5, s[60:63], s38 offen sc0 sc1
    s_mov_b64 exec, s[14:15]
    v_add_u32 v5, 1024000, v5
    v_mov_b32_dpp v7, v24 quad_perm:[0,0,0,0] row_mask:0xf bank_mask:0xf
    v_cmp_ge_u32 vcc, v6, v6
    s_nop 0
    s_and_saveexec_b64 s[14:15], vcc
    buffer_store_dwordx4 v[24:27], v5, s[60:63], s38 offen sc0 sc1
    s_mov_b64 exec, s[14:15]
    v_add_u32 v5, 1024000, v5
    v_mov_b32_dpp v7, v28 quad_perm:[0,0,0,0] row_mask:0xf bank_mask:0xf
    v_cmp_ge_u32 vcc, v6, v6
    v_cmp_gt_u32 s[14:15], s39, v0
    s_nop 0
    s_and_b64 vcc, vcc, s[14:15]
    s_and_saveexec_b64 s[14:15], vcc
    buffer_store_dwordx4 v[28:31], v5, s[60:63], s38 offen sc0 sc1
    s_mov_b64 exec, s[14:15]
    v_cmp_eq_u32 vcc, 0, v0
    s_nop 0
    s_and_saveexec_b64 s[14:15], vcc
    s_lshl_b32 s38, s2, 2
    s_add_u32 s38, s38, 15990784
    v_mov_b32 v6, 0
    buffer_store_dword v8, v6, s[60:63], s38 offen sc0 sc1
    s_mov_b64 exec, s[14:15]
k1_noimg:
    s_endpgm
k1_done:
    s_endpgm
.globl k2_main_kernel
.p2align 8
.type k2_main_kernel,@function
k2_main_kernel:
    s_cmp_ge_u32 s2, 250
    s_cbranch_scc1 k2_done
    s_load_dwordx16 s[16:31], s[0:1], 0
    s_load_dwordx4 s[32:35], s[0:1], 64
    s_load_dwordx2 s[36:37], s[0:1], 80
    v_and_b32 v1, 63, v0
    v_lshrrev_b32 v2, 6, v0
    s_nop 0
    v_readfirstlane_b32 s3, v2
    s_nop 0
    s_lshr_b32 s4, s3, 1
    s_sub_u32 s88, 5, s4
    s_cmp_ge_u32 s3, 4
    s_cselect_b32 s4, s88, s4
    s_and_b32 s5, s3, 1
    s_waitcnt lgkmcnt(0)
    s_mov_b32 s40, s36
    s_mov_b32 s41, s37
    s_mov_b32 s42, 33554432
    s_mov_b32 s43, 0x20000
    s_mov_b32 s66, 0
    s_mov_b32 s67, 0
    s_mov_b32 s27, 0
    s_mov_b32 s15, 0
    s_mov_b32 s64, 0
    s_mov_b32 s65, -1
k2_batch:
    s_cmp_eq_u32 s66, 2
    s_cbranch_scc1 k2_ld_ovf
    v_lshlrev_b32 v15, 4, v0
    s_mul_i32 s88, s2, 16000
    s_add_u32 s88, s88, 10485760
    buffer_load_dwordx4 v[24:27], v15, s[40:43], s88 offen
    v_cmp_gt_u32 vcc, 488, v0
    v_mov_b32 v28, 0
    s_and_saveexec_b64 s[90:91], vcc
    v_add_u32 v16, 8192, v15
    buffer_load_dwordx4 v[28:31], v16, s[40:43], s88 offen
    s_mov_b64 exec, s[90:91]
    s_branch k2_ld_done
k2_ld_ovf:
    v_add_u32 v16, s21, v0
    v_lshlrev_b32 v15, 3, v16
    s_mul_i32 s88, s67, 5120
    s_add_u32 s88, s88, 14680064
    v_mov_b32 v25, -1
    v_cmp_gt_u32 vcc, s97, v16
    s_mov_b32 s89, 160
    v_cmp_gt_u32 s[90:91], s89, v0
    s_nop 0
    s_and_b64 vcc, vcc, s[90:91]
    s_and_saveexec_b64 s[90:91], vcc
    buffer_load_dwordx2 v[24:25], v15, s[40:43], s88 offen
    s_mov_b64 exec, s[90:91]
k2_ld_done:
    v_mov_b32 v7, 0
    v_add_u32 v16, 0, v0
    v_cmp_gt_u32 vcc, 992, v16
    s_nop 0
    s_and_saveexec_b64 s[90:91], vcc
    v_lshlrev_b32 v15, 2, v16
    v_add_u32 v15, 91136, v15
    v_mov_b32 v17, 0x80000000
    ds_write_b32 v15, v7
    ds_write_b32 v15, v7 offset:3968
    ds_write_b32 v15, v17 offset:7936
    s_mov_b64 exec, s[90:91]
    v_add_u32 v16, 512, v0
    v_cmp_gt_u32 vcc, 992, v16
    s_nop 0
    s_and_saveexec_b64 s[90:91], vcc
    v_lshlrev_b32 v15, 2, v16
    v_add_u32 v15, 91136, v15
    v_mov_b32 v17, 0x80000000
    ds_write_b32 v15, v7
    ds_write_b32 v15, v7 offset:3968
    ds_write_b32 v15, v17 offset:7936
    s_mov_b64 exec, s[90:91]
    v_cmp_gt_u32 vcc, 12, v0
    s_nop 0
    s_and_saveexec_b64 s[90:91], vcc
    v_lshlrev_b32 v15, 2, v0
    v_add_u32 v15, 163440, v15
    ds_write_b32 v15, v7
    s_mov_b64 exec, s[90:91]
    s_cmp_eq_u32 s66, 0
    s_cbranch_scc0 k2_re
    s_mov_b32 s44, s36
    s_mov_b32 s45, s37
    s_mov_b32 s46, 5120000
    s_mov_b32 s47, 0x20000
    s_mov_b32 s48, s20
    s_mov_b32 s49, s21
    s_mov_b32 s50, 5120000
    s_mov_b32 s51, 0x20000
    s_mov_b32 s52, s18
    s_mov_b32 s53, s19
    s_mov_b32 s54, 60000
    s_mov_b32 s55, 0x20000
    s_mov_b32 s56, s16
    s_mov_b32 s57, s17
    s_mov_b32 s58, 5120000
    s_mov_b32 s59, 0x20000
    s_mov_b32 s60, s32
    s_mov_b32 s61, s33
    s_mov_b32 s62, 5180000
    s_mov_b32 s63, 0x20000
    s_mov_b32 s68, s28
    s_mov_b32 s69, s29
    s_mov_b32 s70, 512
    s_mov_b32 s71, 0x20000
    v_lshlrev_b32 v15, 2, v0
    v_add_u32 v15, 15990784, v15
    v_cmp_gt_u32 vcc, 250, v0
    v_mov_b32 v20, 0
    s_and_saveexec_b64 s[90:91], vcc
    buffer_load_dword v20, v15, s[40:43], 0 offen
    s_mov_b64 exec, s[90:91]
    s_mul_i32 s88, s2, 40
    v_add_u32 v16, s88, v0
    v_mul_u32_u24 v17, 6, v16
    v_and_b32 v17, -4, v17
    v_cmp_gt_u32 vcc, 40, v0
    s_nop 0
    s_and_saveexec_b64 s[90:91], vcc
    buffer_load_dwordx2 v[18:19], v17, s[52:55], 0 offen
    s_mov_b64 exec, s[90:91]
    s_lshl_b32 s88, s3, 11
    s_add_u32 s88, s88, 74752
    v_lshlrev_b32 v4, 4, v1
    v_add_u32 v4, s88, v4
    v_mov_b32 v200, 0
    v_mov_b32 v201, 0
    v_mov_b32 v202, 0
    v_mov_b32 v203, 0
    ds_write_b128 v4, v[200:203]
    ds_write_b128 v4, v[200:203] offset:1024
    v_cmp_gt_u32 vcc, 120, v0
    s_nop 0
    s_and_saveexec_b64 s[90:91], vcc
    v_lshlrev_b32 v16, 2, v0
    v_add_u32 v16, 162816, v16
    ds_write_b32 v16, v7
    s_mov_b64 exec, s[90:91]
    v_cmp_gt_u32 vcc, 72, v0
    s_nop 0
    s_and_saveexec_b64 s[90:91], vcc
    v_lshrrev_b32 v16, 3, v0
    v_and_b32 v17, 7, v0
    v_cmp_eq_u32 vcc, v16, v17
    v_mov_b32 v17, 0x3f80
    s_nop 0
    v_cndmask_b32 v17, 0, v17, vcc
    v_lshlrev_b32 v16, 1, v0
    v_add_u32 v16, 163296, v16
    ds_write_b16 v16, v17
    s_mov_b64 exec, s[90:91]
    s_waitcnt lgkmcnt(0)
    s_barrier
    v_lshlrev_b32 v12, 4, v1
    s_mul_i32 s88, s2, 20480
    s_add_u32 s88, s88, 5242880
    s_lshl_b32 s89, s3, 10
    s_add_u32 s89, s89, 0
    s_add_u32 m0, s89, 108032
    s_add_u32 s89, s89, s88
    buffer_load_dwordx4 v12, s[40:43], s89 offen lds
    s_lshl_b32 s89, s3, 10
    s_add_u32 s89, s89, 8192
    s_add_u32 m0, s89, 108032
    s_add_u32 s89, s89, s88
    buffer_load_dwordx4 v12, s[40:43], s89 offen lds
    s_lshl_b32 s89, s3, 10
    s_add_u32 s89, s89, 16384
    s_cmp_ge_u32 s3, 4
    s_cbranch_scc1 k2_noat
    s_add_u32 m0, s89, 108032
    s_add_u32 s89, s89, s88
    buffer_load_dwordx4 v12, s[40:43], s89 offen lds
k2_noat:
    v_lshlrev_b32 v12, 4, v1
    s_lshl_b32 s88, s5, 12
    s_add_u32 s88, s88, 16056320
    buffer_load_dwordx4 v[144:147], v12, s[40:43], s88 offen offset:0
    buffer_load_dwordx4 v[148:151], v12, s[40:43], s88 offen offset:1024
    buffer_load_dwordx4 v[152:155], v12, s[40:43], s88 offen offset:2048
    buffer_load_dwordx4 v[156:159], v12, s[40:43], s88 offen offset:3072
    v_and_b32 v13, 31, v1
    v_lshrrev_b32 v14, 5, v1
    s_lshl_b32 s88, s5, 8
    v_lshlrev_b32 v15, 1, v13
    buffer_load_ushort v224, v15, s[68:71], s88 offen offset:0
    buffer_load_ushort v225, v15, s[68:71], s88 offen offset:64
    buffer_load_ushort v226, v15, s[68:71], s88 offen offset:128
    buffer_load_ushort v227, v15, s[68:71], s88 offen offset:192
    s_lshl_b32 s88, s5, 11
    s_add_u32 s88, s88, 16064512
    v_lshlrev_b32 v15, 4, v13
    buffer_load_dword v160, v15, s[40:43], s88 offen offset:0
    v_mov_b32 v161, 0
    v_mov_b32 v162, 0
    v_mov_b32 v163, 0
    buffer_load_dword v164, v15, s[40:43], s88 offen offset:512
    v_mov_b32 v165, 0
    v_mov_b32 v166, 0
    v_mov_b32 v167, 0
    buffer_load_dword v168, v15, s[40:43], s88 offen offset:1024
    v_mov_b32 v169, 0
    v_mov_b32 v170, 0
    v_mov_b32 v171, 0
    buffer_load_dword v172, v15, s[40:43], s88 offen offset:1536
    v_mov_b32 v173, 0
    v_mov_b32 v174, 0
    v_mov_b32 v175, 0
    s_mov_b32 s92, 0xbfb8aa3b
    s_lshl_b32 s86, s5, 8
    s_mul_i32 s87, s3, 8320
    s_lshl_b32 s39, s3, 10
    s_add_u32 s39, s39, 66560
    v_lshlrev_b32 v243, 2, v13
    v_add_u32 v243, 99072, v243
    v_add_u32 v244, 107008, v13
    v_lshrrev_b32 v242, 1, v1
    v_lshlrev_b32 v242, 2, v242
    v_add_u32 v242, 95104, v242
    v_and_b32 v245, 1, v1
    v_lshlrev_b32 v245, 4, v245
    v_lshlrev_b32 v8, 5, v13
    v_lshl_add_u32 v8, v14, 4, v8
    v_add_u32 v8, s39, v8
    v_lshrrev_b32 v2, 4, v1
    v_lshlrev_b32 v2, 5, v2
    v_add_u32 v2, 91136, v2
    v_bfe_u32 v16, v13, 4, 1
    v_lshlrev_b32 v3, 10, v16
    v_bfe_u32 v16, v13, 2, 1
    v_lshl_add_u32 v3, v16, 9, v3
    v_bfe_u32 v16, v13, 3, 1
    v_lshl_add_u32 v3, v16, 3, v3
    v_and_b32 v16, 3, v13
    v_lshl_add_u32 v3, v16, 1, v3
    v_lshl_add_u32 v3, v14, 5, v3
    s_lshl_b32 s88, s3, 11
    s_add_u32 s88, s88, 74752
    v_add_u32 v3, s88, v3
    v_and_b32 v16, 7, v13
    v_mul_u32_u24 v5, 1040, v16
    v_lshrrev_b32 v16, 3, v13
    v_lshl_add_u32 v5, v16, 8, v5
    v_lshl_add_u32 v5, v14, 4, v5
    v_add_u32 v5, s87, v5
    v_and_b32 v16, 15, v1
    v_lshlrev_b32 v6, 4, v16
    s_lshl_b32 s88, s5, 7
    v_add_u32 v16, s88, v13
    v_lshlrev_b32 v16, 4, v16
    v_add_u32 v9, 108032, v16
    v_mov_b32 v247, 163296
    v_mov_b32 v248, 163424
    v_lshrrev_b32 v16, 4, v1
    v_bfe_u32 v17, v1, 2, 2
    v_and_b32 v21, 1, v17
    v_lshrrev_b32 v22, 1, v17
    v_lshl_add_u32 v21, v21, 1, v22
    v_and_b32 v23, 1, v16
    v_lshl_add_u32 v21, v21, 1, v23
    v_lshl_add_u32 v22, v22, 1, v23
    v_add_u32 v22, 8, v22
    v_lshrrev_b32 v16, 1, v16
    v_mul_u32_u24 v16, 12, v16
    v_add_u32 v21, v21, v16
    v_add_u32 v22, v22, v16
    v_lshlrev_b32 v240, 2, v21
    v_lshlrev_b32 v241, 2, v22
    v_and_b32 v13, 31, v1
    v_lshrrev_b32 v14, 5, v1
    v_lshlrev_b32 v16, 3, v14
    v_sub_u32 v16, v13, v16
    v_cmp_eq_u32 vcc, 0, v16
    v_mov_b32 v17, 0x3f80
    s_nop 0
    v_cndmask_b32 v21, 0, v17, vcc
    v_cmp_eq_u32 vcc, 1, v16
    v_mov_b32 v17, 0x3f800000
    s_nop 0
    v_cndmask_b32 v176, v21, v17, vcc
    v_cmp_eq_u32 vcc, 2, v16
    v_mov_b32 v17, 0x3f80
    s_nop 0
    v_cndmask_b32 v21, 0, v17, vcc
    v_cmp_eq_u32 vcc, 3, v16
    v_mov_b32 v17, 0x3f800000
    s_nop 0
    v_cndmask_b32 v177, v21, v17, vcc
    v_cmp_eq_u32 vcc, 4, v16
    v_mov_b32 v17, 0x3f80
    s_nop 0
    v_cndmask_b32 v21, 0, v17, vcc
    v_cmp_eq_u32 vcc, 5, v16
    v_mov_b32 v17, 0x3f800000
    s_nop 0
    v_cndmask_b32 v178, v21, v17, vcc
    v_cmp_eq_u32 vcc, 6, v16
    v_mov_b32 v17, 0x3f80
    s_nop 0
    v_cndmask_b32 v21, 0, v17, vcc
    v_cmp_eq_u32 vcc, 7, v16
    v_mov_b32 v17, 0x3f800000
    s_nop 0
    v_cndmask_b32 v179, v21, v17, vcc
    v_cmp_eq_u32 vcc, 16, v16
    v_mov_b32 v17, 0x3f80
    s_nop 0
    v_cndmask_b32 v21, 0, v17, vcc
    v_cmp_eq_u32 vcc, 17, v16
    v_mov_b32 v17, 0x3f800000
    s_nop 0
    v_cndmask_b32 v180, v21, v17, vcc
    v_cmp_eq_u32 vcc, 18, v16
    v_mov_b32 v17, 0x3f80
    s_nop 0
    v_cndmask_b32 v21, 0, v17, vcc
    v_cmp_eq_u32 vcc, 19, v16
    v_mov_b32 v17, 0x3f800000
    s_nop 0
    v_cndmask_b32 v181, v21, v17, vcc
    v_cmp_eq_u32 vcc, 20, v16
    v_mov_b32 v17, 0x3f80
    s_nop 0
    v_cndmask_b32 v21, 0, v17, vcc
    v_cmp_eq_u32 vcc, 21, v16
    v_mov_b32 v17, 0x3f800000
    s_nop 0
    v_cndmask_b32 v182, v21, v17, vcc
    v_cmp_eq_u32 vcc, 22, v16
    v_mov_b32 v17, 0x3f80
    s_nop 0
    v_cndmask_b32 v21, 0, v17, vcc
    v_cmp_eq_u32 vcc, 23, v16
    v_mov_b32 v17, 0x3f800000
    s_nop 0
    v_cndmask_b32 v183, v21, v17, vcc
    v_mov_b32 v192, 0
    v_mov_b32 v193, 0
    v_mov_b32 v194, 0
    v_mov_b32 v195, 0
    s_waitcnt vmcnt(14)
    s_mul_i32 s88, s2, 40
    v_add_u32 v16, s88, v0
    v_and_b32 v16, 1, v16
    v_lshlrev_b32 v16, 4, v16
    v_alignbit_b32 v22, v19, v18, v16
    v_lshrrev_b32 v23, v16, v19
    v_lshlrev_b32 v15, 3, v0
    v_add_u32 v15, 163488, v15
    v_cmp_gt_u32 vcc, 40, v0
    s_nop 0
    s_and_saveexec_b64 s[90:91], vcc
    ds_write_b64 v15, v[22:23]
    s_mov_b64 exec, s[90:91]
    v_cmp_ne_u32 vcc, 0, v20
    s_cbranch_vccz k2_later
    v_mov_b32 v15, 163472
    v_mov_b32 v16, 1
    ds_write_b32 v15, v16
    s_branch k2_later
k2_re:
    v_lshlrev_b32 v12, 4, v1
    s_lshl_b32 s88, s5, 12
    s_add_u32 s88, s88, 16056320
    buffer_load_dwordx4 v[144:147], v12, s[40:43], s88 offen offset:0
    buffer_load_dwordx4 v[148:151], v12, s[40:43], s88 offen offset:1024
    buffer_load_dwordx4 v[152:155], v12, s[40:43], s88 offen offset:2048
    buffer_load_dwordx4 v[156:159], v12, s[40:43], s88 offen offset:3072
    v_and_b32 v13, 31, v1
    v_lshrrev_b32 v14, 5, v1
    s_lshl_b32 s88, s5, 8
    v_lshlrev_b32 v15, 1, v13
    s_lshl_b32 s88, s5, 11
    s_add_u32 s88, s88, 16064512
    v_lshlrev_b32 v15, 4, v13
    buffer_load_dword v160, v15, s[40:43], s88 offen offset:0
    v_mov_b32 v161, 0
    v_mov_b32 v162, 0
    v_mov_b32 v163, 0
    buffer_load_dword v164, v15, s[40:43], s88 offen offset:512
    v_mov_b32 v165, 0
    v_mov_b32 v166, 0
    v_mov_b32 v167, 0
    buffer_load_dword v168, v15, s[40:43], s88 offen offset:1024
    v_mov_b32 v169, 0
    v_mov_b32 v170, 0
    v_mov_b32 v171, 0
    buffer_load_dword v172, v15, s[40:43], s88 offen offset:1536
    v_mov_b32 v173, 0
    v_mov_b32 v174, 0
    v_mov_b32 v175, 0
    v_and_b32 v13, 31, v1
    v_lshrrev_b32 v14, 5, v1
    v_lshlrev_b32 v16, 3, v14
    v_sub_u32 v16, v13, v16
    v_cmp_eq_u32 vcc, 0, v16
    v_mov_b32 v17, 0x3f80
    s_nop 0
    v_cndmask_b32 v21, 0, v17, vcc
    v_cmp_eq_u32 vcc, 1, v16
    v_mov_b32 v17, 0x3f800000
    s_nop 0
    v_cndmask_b32 v176, v21, v17, vcc
    v_cmp_eq_u32 vcc, 2, v16
    v_mov_b32 v17, 0x3f80
    s_nop 0
    v_cndmask_b32 v21, 0, v17, vcc
    v_cmp_eq_u32 vcc, 3, v16
    v_mov_b32 v17, 0x3f800000
    s_nop 0
    v_cndmask_b32 v177, v21, v17, vcc
    v_cmp_eq_u32 vcc, 4, v16
    v_mov_b32 v17, 0x3f80
    s_nop 0
    v_cndmask_b32 v21, 0, v17, vcc
    v_cmp_eq_u32 vcc, 5, v16
    v_mov_b32 v17, 0x3f800000
    s_nop 0
    v_cndmask_b32 v178, v21, v17, vcc
    v_cmp_eq_u32 vcc, 6, v16
    v_mov_b32 v17, 0x3f80
    s_nop 0
    v_cndmask_b32 v21, 0, v17, vcc
    v_cmp_eq_u32 vcc, 7, v16
    v_mov_b32 v17, 0x3f800000
    s_nop 0
    v_cndmask_b32 v179, v21, v17, vcc
    v_cmp_eq_u32 vcc, 16, v16
    v_mov_b32 v17, 0x3f80
    s_nop 0
    v_cndmask_b32 v21, 0, v17, vcc
    v_cmp_eq_u32 vcc, 17, v16
    v_mov_b32 v17, 0x3f800000
    s_nop 0
    v_cndmask_b32 v180, v21, v17, vcc
    v_cmp_eq_u32 vcc, 18, v16
    v_mov_b32 v17, 0x3f80
    s_nop 0
    v_cndmask_b32 v21, 0, v17, vcc
    v_cmp_eq_u32 vcc, 19, v16
    v_mov_b32 v17, 0x3f800000
    s_nop 0
    v_cndmask_b32 v181, v21, v17, vcc
    v_cmp_eq_u32 vcc, 20, v16
    v_mov_b32 v17, 0x3f80
    s_nop 0
    v_cndmask_b32 v21, 0, v17, vcc
    v_cmp_eq_u32 vcc, 21, v16
    v_mov_b32 v17, 0x3f800000
    s_nop 0
    v_cndmask_b32 v182, v21, v17, vcc
    v_cmp_eq_u32 vcc, 22, v16
    v_mov_b32 v17, 0x3f80
    s_nop 0
    v_cndmask_b32 v21, 0, v17, vcc
    v_cmp_eq_u32 vcc, 23, v16
    v_mov_b32 v17, 0x3f800000
    s_nop 0
    v_cndmask_b32 v183, v21, v17, vcc
    v_mov_b32 v192, 0
    v_mov_b32 v193, 0
    v_mov_b32 v194, 0
    v_mov_b32 v195, 0
    s_waitcnt vmcnt(0) lgkmcnt(0)
    s_barrier
k2_later:
    s_cmp_eq_u32 s66, 2
    s_cbranch_scc1 k2_v_ovf
    v_lshrrev_b32 v21, 2, v0
    v_add_u32 v22, 128, v21
    v_mov_b32_dpp v18, v24 quad_perm:[0,0,0,0] row_mask:0xf bank_mask:0xf
    v_mov_b32_dpp v19, v28 quad_perm:[0,0,0,0] row_mask:0xf bank_mask:0xf
    v_and_b32 v15, 3, v0
    v_lshlrev_b32 v15, 2, v15
    v_subrev_u32 v15, 1, v15
    v_min_u32 v18, 15, v18
    v_sub_i32 v18, v18, v15
    v_min_u32 v19, 15, v19
    v_sub_i32 v19, v19, v15
    s_cmp_eq_u32 s66, 1
    s_cbranch_scc0 k2_v_done
    v_subrev_u32 v15, s67, v21
    v_cmp_gt_u32 vcc, 12, v15
    s_nop 1
    v_cndmask_b32 v18, 0, v18, vcc
    v_subrev_u32 v15, s67, v22
    v_cmp_gt_u32 vcc, 12, v15
    s_nop 1
    v_cndmask_b32 v19, 0, v19, vcc
    s_branch k2_v_done
k2_v_ovf:
    v_mov_b32 v21, s67
    v_mov_b32 v22, s67
    v_cmp_eq_u32 vcc, s2, v25
    s_nop 1
    v_cndmask_b32 v18, 0, 1, vcc
    v_mov_b32 v19, 0
k2_v_done:
    v_mul_u32_u24 v21, 640, v21
    v_mul_u32_u24 v22, 640, v22
    v_cmp_lt_i32 s[72:73], 0, v18
    v_cmp_lt_i32 s[74:75], 1, v18
    v_cmp_lt_i32 s[76:77], 2, v18
    v_cmp_lt_i32 s[80:81], 3, v18
    v_cmp_lt_i32 s[82:83], 0, v19
    v_cmp_lt_i32 s[88:89], 1, v19
    v_cmp_lt_i32 s[90:91], 2, v19
    v_cmp_lt_i32 s[94:95], 3, v19
    s_mov_b32 s10, 0xeeeeeeee
    s_mov_b32 s11, 0xeeeeeeee
    s_cmp_eq_u32 s66, 2
    s_cselect_b32 s10, -1, s10
    s_cselect_b32 s11, -1, s11
    s_and_b64 s[72:73], s[72:73], s[10:11]
    s_and_b64 s[82:83], s[82:83], s[10:11]
    v_bfe_u32 v32, v24, 17, 3
    v_lshlrev_b32 v40, 2, v32
    v_add_u32 v40, 163440, v40
    v_bfe_u32 v33, v25, 17, 3
    v_lshlrev_b32 v41, 2, v33
    v_add_u32 v41, 163440, v41
    v_bfe_u32 v34, v26, 17, 3
    v_lshlrev_b32 v42, 2, v34
    v_add_u32 v42, 163440, v42
    v_bfe_u32 v35, v27, 17, 3
    v_lshlrev_b32 v43, 2, v35
    v_add_u32 v43, 163440, v43
    v_bfe_u32 v36, v28, 17, 3
    v_lshlrev_b32 v44, 2, v36
    v_add_u32 v44, 163440, v44
    v_bfe_u32 v37, v29, 17, 3
    v_lshlrev_b32 v45, 2, v37
    v_add_u32 v45, 163440, v45
    v_bfe_u32 v38, v30, 17, 3
    v_lshlrev_b32 v46, 2, v38
    v_add_u32 v46, 163440, v46
    v_bfe_u32 v39, v31, 17, 3
    v_lshlrev_b32 v47, 2, v39
    v_add_u32 v47, 163440, v47
    v_mov_b32 v16, 1
    s_mov_b64 exec, s[72:73]
    ds_add_rtn_u32 v200, v40, v16
    s_mov_b64 exec, s[74:75]
    ds_add_rtn_u32 v201, v41, v16
    s_mov_b64 exec, s[76:77]
    ds_add_rtn_u32 v202, v42, v16
    s_mov_b64 exec, s[80:81]
    ds_add_rtn_u32 v203, v43, v16
    s_mov_b64 exec, s[82:83]
    ds_add_rtn_u32 v204, v44, v16
    s_mov_b64 exec, s[88:89]
    ds_add_rtn_u32 v205, v45, v16
    s_mov_b64 exec, s[90:91]
    ds_add_rtn_u32 v206, v46, v16
    s_mov_b64 exec, s[94:95]
    ds_add_rtn_u32 v207, v47, v16
    s_mov_b64 exec, -1
    v_and_b32 v48, 0x3fff, v24
    v_lshlrev_b32 v48, 9, v48
    v_lshrrev_b32 v56, 20, v24
    v_add_u32 v56, v56, v21
    v_mul_u32_u24 v32, 768, v32
    v_add_u32 v32, 91136, v32
    v_and_b32 v49, 0x3fff, v25
    v_lshlrev_b32 v49, 9, v49
    v_lshrrev_b32 v57, 20, v25
    v_add_u32 v57, v57, v21
    v_mul_u32_u24 v33, 768, v33
    v_add_u32 v33, 91136, v33
    v_and_b32 v50, 0x3fff, v26
    v_lshlrev_b32 v50, 9, v50
    v_lshrrev_b32 v58, 20, v26
    v_add_u32 v58, v58, v21
    v_mul_u32_u24 v34, 768, v34
    v_add_u32 v34, 91136, v34
    v_and_b32 v51, 0x3fff, v27
    v_lshlrev_b32 v51, 9, v51
    v_lshrrev_b32 v59, 20, v27
    v_add_u32 v59, v59, v21
    v_mul_u32_u24 v35, 768, v35
    v_add_u32 v35, 91136, v35
    v_and_b32 v52, 0x3fff, v28
    v_lshlrev_b32 v52, 9, v52
    v_lshrrev_b32 v60, 20, v28
    v_add_u32 v60, v60, v22
    v_mul_u32_u24 v36, 768, v36
    v_add_u32 v36, 91136, v36
    v_and_b32 v53, 0x3fff, v29
    v_lshlrev_b32 v53, 9, v53
    v_lshrrev_b32 v61, 20, v29
    v_add_u32 v61, v61, v22
    v_mul_u32_u24 v37, 768, v37
    v_add_u32 v37, 91136, v37
    v_and_b32 v54, 0x3fff, v30
    v_lshlrev_b32 v54, 9, v54
    v_lshrrev_b32 v62, 20, v30
    v_add_u32 v62, v62, v22
    v_mul_u32_u24 v38, 768, v38
    v_add_u32 v38, 91136, v38
    v_and_b32 v55, 0x3fff, v31
    v_lshlrev_b32 v55, 9, v55
    v_lshrrev_b32 v63, 20, v31
    v_add_u32 v63, v63, v22
    v_mul_u32_u24 v39, 768, v39
    v_add_u32 v39, 91136, v39
    s_waitcnt lgkmcnt(0)
    v_min_u32 v200, 191, v200
    v_lshl_add_u32 v32, v200, 2, v32
    v_min_u32 v201, 191, v201
    v_lshl_add_u32 v33, v201, 2, v33
    v_min_u32 v202, 191, v202
    v_lshl_add_u32 v34, v202, 2, v34
    v_min_u32 v203, 191, v203
    v_lshl_add_u32 v35, v203, 2, v35
    v_min_u32 v204, 191, v204
    v_lshl_add_u32 v36, v204, 2, v36
    v_min_u32 v205, 191, v205
    v_lshl_add_u32 v37, v205, 2, v37
    v_min_u32 v206, 191, v206
    v_lshl_add_u32 v38, v206, 2, v38
    v_min_u32 v207, 191, v207
    v_lshl_add_u32 v39, v207, 2, v39
    s_mov_b64 exec, s[72:73]
    ds_write_b32 v32, v48
    ds_write_b32 v32, v56 offset:3968
    ds_write_b32 v32, v24 offset:7936
    s_mov_b64 exec, s[74:75]
    ds_write_b32 v33, v49
    ds_write_b32 v33, v57 offset:3968
    ds_write_b32 v33, v25 offset:7936
    s_mov_b64 exec, s[76:77]
    ds_write_b32 v34, v50
    ds_write_b32 v34, v58 offset:3968
    ds_write_b32 v34, v26 offset:7936
    s_mov_b64 exec, s[80:81]
    ds_write_b32 v35, v51
    ds_write_b32 v35, v59 offset:3968
    ds_write_b32 v35, v27 offset:7936
    s_mov_b64 exec, s[82:83]
    ds_write_b32 v36, v52
    ds_write_b32 v36, v60 offset:3968
    ds_write_b32 v36, v28 offset:7936
    s_mov_b64 exec, s[88:89]
    ds_write_b32 v37, v53
    ds_write_b32 v37, v61 offset:3968
    ds_write_b32 v37, v29 offset:7936
    s_mov_b64 exec, s[90:91]
    ds_write_b32 v38, v54
    ds_write_b32 v38, v62 offset:3968
    ds_write_b32 v38, v30 offset:7936
    s_mov_b64 exec, s[94:95]
    ds_write_b32 v39, v55
    ds_write_b32 v39, v63 offset:3968
    ds_write_b32 v39, v31 offset:7936
    s_mov_b64 exec, -1
    s_waitcnt lgkmcnt(0)
    s_barrier
    s_lshl_b32 s89, s3, 6
    v_add_u32 v16, s89, v1
    v_min_u32 v16, 991, v16
    v_lshlrev_b32 v15, 2, v16
    v_add_u32 v112, 99072, v15
    ds_read_b32 v113, v112
    s_lshl_b32 s89, s3, 6
    s_add_u32 s89, s89, 512
    v_add_u32 v16, s89, v1
    v_min_u32 v16, 991, v16
    v_lshlrev_b32 v15, 2, v16
    v_add_u32 v120, 99072, v15
    ds_read_b32 v121, v120
    v_mov_b32 v15, 163440
    ds_read_b128 v[24:27], v15
    ds_read_b32 v28, v15 offset:16
    ds_read_b32 v29, v15 offset:32
    s_waitcnt lgkmcnt(0)
    v_and_b32 v16, 0x3fff, v113
    v_mul_u32_u24 v16, 6, v16
    v_and_b32 v16, -4, v16
    v_cmp_le_i32 vcc, 0, v113
    v_mov_b32 v114, 0
    v_mov_b32 v115, 0
    s_and_saveexec_b64 s[90:91], vcc
    buffer_load_dwordx2 v[114:115], v16, s[52:55], 0 offen
    s_mov_b64 exec, s[90:91]
    v_bfe_u32 v16, v113, 14, 6
    v_lshlrev_b32 v16, 3, v16
    v_add_u32 v16, 163488, v16
    ds_read_b64 v[116:117], v16
    v_and_b32 v16, 0x3fff, v121
    v_mul_u32_u24 v16, 6, v16
    v_and_b32 v16, -4, v16
    v_cmp_le_i32 vcc, 0, v121
    v_mov_b32 v122, 0
    v_mov_b32 v123, 0
    s_and_saveexec_b64 s[90:91], vcc
    buffer_load_dwordx2 v[122:123], v16, s[52:55], 0 offen
    s_mov_b64 exec, s[90:91]
    v_bfe_u32 v16, v121, 14, 6
    v_lshlrev_b32 v16, 3, v16
    v_add_u32 v16, 163488, v16
    ds_read_b64 v[124:125], v16
    s_mov_b32 s72, 0
    v_readfirstlane_b32 s88, v24
    s_nop 0
    s_mov_b32 s91, s88
    s_add_u32 s89, s88, 7
    s_and_b32 s22, s89, -8
    s_add_u32 s89, s88, 31
    s_lshr_b32 s89, s89, 5
    s_add_u32 s73, s72, s89
    v_readfirstlane_b32 s88, v25
    s_nop 0
    s_max_u32 s91, s91, s88
    s_add_u32 s89, s88, 7
    s_and_b32 s23, s89, -8
    s_add_u32 s89, s88, 31
    s_lshr_b32 s89, s89, 5
    s_add_u32 s74, s73, s89
    v_readfirstlane_b32 s88, v26
    s_nop 0
    s_max_u32 s91, s91, s88
    s_add_u32 s89, s88, 7
    s_and_b32 s24, s89, -8
    s_add_u32 s89, s88, 31
    s_lshr_b32 s89, s89, 5
    s_add_u32 s75, s74, s89
    v_readfirstlane_b32 s88, v27
    s_nop 0
    s_max_u32 s91, s91, s88
    s_add_u32 s89, s88, 7
    s_and_b32 s25, s89, -8
    s_add_u32 s89, s88, 31
    s_lshr_b32 s89, s89, 5
    s_add_u32 s76, s75, s89
    v_readfirstlane_b32 s88, v28
    s_nop 0
    s_max_u32 s91, s91, s88
    s_add_u32 s89, s88, 7
    s_and_b32 s26, s89, -8
    s_add_u32 s89, s88, 31
    s_lshr_b32 s89, s89, 5
    s_add_u32 s77, s76, s89
    s_cmp_eq_u32 s66, 0
    s_cbranch_scc0 k2_noflag2
    v_readfirstlane_b32 s85, v29
k2_noflag2:
    s_cmp_gt_u32 s91, 192
    s_cselect_b32 s93, 1, 0
    s_cbranch_scc1 k2_nofit1
    s_mov_b32 s88, 0
    s_mov_b32 s89, 23
    s_cmp_eq_u32 s4, 1
    s_cselect_b32 s88, 23, s88
    s_cselect_b32 s89, 46, s89
    s_cmp_eq_u32 s4, 2
    s_cselect_b32 s88, 46, s88
    s_cselect_b32 s89, 55, s89
    s_cmp_eq_u32 s4, 3
    s_cselect_b32 s88, 55, s88
    s_cselect_b32 s89, 64, s89
    s_mul_i32 s88, s77, s88
    s_lshr_b32 s28, s88, 6
    s_mul_i32 s89, s77, s89
    s_lshr_b32 s79, s89, 6
    v_add_u32 v16, s28, v1
    v_mov_b32 v17, 0
    v_mov_b32 v18, s72
    v_mov_b32 v19, s73
    v_mov_b32 v20, s22
    v_cmp_le_u32 vcc, s73, v16
    v_mov_b32 v21, 1
    s_nop 0
    v_cndmask_b32 v17, v17, v21, vcc
    v_mov_b32 v21, s73
    v_cndmask_b32 v18, v18, v21, vcc
    v_mov_b32 v21, s74
    v_cndmask_b32 v19, v19, v21, vcc
    v_mov_b32 v21, s23
    v_cndmask_b32 v20, v20, v21, vcc
    v_cmp_le_u32 vcc, s74, v16
    v_mov_b32 v21, 2
    s_nop 0
    v_cndmask_b32 v17, v17, v21, vcc
    v_mov_b32 v21, s74
    v_cndmask_b32 v18, v18, v21, vcc
    v_mov_b32 v21, s75
    v_cndmask_b32 v19, v19, v21, vcc
    v_mov_b32 v21, s24
    v_cndmask_b32 v20, v20, v21, vcc
    v_cmp_le_u32 vcc, s75, v16
    v_mov_b32 v21, 3
    s_nop 0
    v_cndmask_b32 v17, v17, v21, vcc
    v_mov_b32 v21, s75
    v_cndmask_b32 v18, v18, v21, vcc
    v_mov_b32 v21, s76
    v_cndmask_b32 v19, v19, v21, vcc
    v_mov_b32 v21, s25
    v_cndmask_b32 v20, v20, v21, vcc
    v_cmp_le_u32 vcc, s76, v16
    v_mov_b32 v21, 4
    s_nop 0
    v_cndmask_b32 v17, v17, v21, vcc
    v_mov_b32 v21, s76
    v_cndmask_b32 v18, v18, v21, vcc
    v_mov_b32 v21, s77
    v_cndmask_b32 v19, v19, v21, vcc
    v_mov_b32 v21, s26
    v_cndmask_b32 v20, v20, v21, vcc
    v_sub_u32 v18, v16, v18
    v_lshlrev_b32 v18, 5, v18
    v_sub_u32 v20, v20, v18
    v_min_u32 v20, 32, v20
    v_mul_u32_u24 v21, 192, v17
    v_add_u32 v18, v18, v21
    v_min_u32 v19, s79, v19
    v_add_u32 v21, 1, v16
    v_cmp_ge_u32 vcc, v21, v19
    s_nop 1
    v_cndmask_b32 v21, 0, 1, vcc
    v_lshl_or_b32 v246, v20, 10, v18
    v_lshl_or_b32 v246, v17, 16, v246
    v_lshl_or_b32 v246, v21, 19, v246
    v_or_b32 v246, 0x100000, v246
    v_cmp_eq_u32 vcc, 32, v20
    v_or_b32 v21, 0x200000, v246
    s_nop 0
    v_cndmask_b32 v246, v246, v21, vcc
    v_cmp_gt_u32 vcc, s79, v16
    v_mov_b32 v21, 0x208000
    s_nop 0
    v_cndmask_b32 v246, v21, v246, vcc
    s_nop 0
    v_readlane_b32 s78, v246, 0
    v_readlane_b32 s94, v246, 1
    v_readlane_b32 s6, v246, 2
    s_mov_b32 s30, 2
    s_and_b32 s88, s78, 0x3ff
    s_lshl_b32 s88, s88, 2
    v_add_u32 v10, s88, v2
    ds_read_b128 v[208:211], v10
    ds_read_b128 v[212:215], v10 offset:16
    v_add_u32 v12, s88, v242
    ds_read_b32 v221, v12
    s_waitcnt lgkmcnt(0)
    s_mov_b32 m0, s39
    v_lshl_add_u32 v11, v221, 5, v245
    buffer_load_dwordx4 v11, s[48:51], 0 offen lds
    s_add_u32 m0, s87, 0
    v_add_u32 v208, v6, v208
    buffer_load_dwordx4 v208, s[44:47], s86 offen lds
    s_add_u32 m0, s87, 1040
    v_add_u32 v209, v6, v209
    buffer_load_dwordx4 v209, s[44:47], s86 offen lds
    s_add_u32 m0, s87, 2080
    v_add_u32 v210, v6, v210
    buffer_load_dwordx4 v210, s[44:47], s86 offen lds
    s_add_u32 m0, s87, 3120
    v_add_u32 v211, v6, v211
    buffer_load_dwordx4 v211, s[44:47], s86 offen lds
    s_add_u32 m0, s87, 4160
    v_add_u32 v212, v6, v212
    buffer_load_dwordx4 v212, s[44:47], s86 offen lds
    s_add_u32 m0, s87, 5200
    v_add_u32 v213, v6, v213
    buffer_load_dwordx4 v213, s[44:47], s86 offen lds
    s_add_u32 m0, s87, 6240
    v_add_u32 v214, v6, v214
    buffer_load_dwordx4 v214, s[44:47], s86 offen lds
    s_add_u32 m0, s87, 7280
    v_add_u32 v215, v6, v215
    buffer_load_dwordx4 v215, s[44:47], s86 offen lds
    s_bfe_u32 s80, s78, 0x30010
    s_mov_b32 s38, s72
    s_cmp_eq_u32 s80, 1
    s_cselect_b32 s38, s73, s38
    s_cmp_eq_u32 s80, 2
    s_cselect_b32 s38, s74, s38
    s_cmp_eq_u32 s80, 3
    s_cselect_b32 s38, s75, s38
    s_cmp_eq_u32 s80, 4
    s_cselect_b32 s38, s76, s38
    s_cmp_gt_u32 s28, s38
    s_cselect_b32 s38, 1, 0
k2_nofit1:
    s_cmp_eq_u32 s93, 0
    s_cbranch_scc1 k2_fits
    s_mov_b32 s66, 1
    s_mov_b32 s67, 0
    s_waitcnt vmcnt(0) lgkmcnt(0)
    s_barrier
    s_branch k2_batch
k2_fits:
    v_pk_mov_b32 v[16:17], 0, 0
    v_pk_mov_b32 v[18:19], 0, 0
    v_pk_mov_b32 v[20:21], 0, 0
    v_pk_mov_b32 v[22:23], 0, 0
    v_pk_mov_b32 v[24:25], 0, 0
    v_pk_mov_b32 v[26:27], 0, 0
    v_pk_mov_b32 v[28:29], 0, 0
    v_pk_mov_b32 v[30:31], 0, 0
    v_pk_mov_b32 v[32:33], 0, 0
    v_pk_mov_b32 v[34:35], 0, 0
    v_pk_mov_b32 v[36:37], 0, 0
    v_pk_mov_b32 v[38:39], 0, 0
    v_pk_mov_b32 v[40:41], 0, 0
    v_pk_mov_b32 v[42:43], 0, 0
    v_pk_mov_b32 v[44:45], 0, 0
    v_pk_mov_b32 v[46:47], 0, 0
    v_pk_mov_b32 v[48:49], 0, 0
    v_pk_mov_b32 v[50:51], 0, 0
    v_pk_mov_b32 v[52:53], 0, 0
    v_pk_mov_b32 v[54:55], 0, 0
    v_pk_mov_b32 v[56:57], 0, 0
    v_pk_mov_b32 v[58:59], 0, 0
    v_pk_mov_b32 v[60:61], 0, 0
    v_pk_mov_b32 v[62:63], 0, 0
    v_pk_mov_b32 v[64:65], 0, 0
    v_pk_mov_b32 v[66:67], 0, 0
    v_pk_mov_b32 v[68:69], 0, 0
    v_pk_mov_b32 v[70:71], 0, 0
    v_pk_mov_b32 v[72:73], 0, 0
    v_pk_mov_b32 v[74:75], 0, 0
    v_pk_mov_b32 v[76:77], 0, 0
    v_pk_mov_b32 v[78:79], 0, 0
    v_mov_b32 v184, 0
    v_mov_b32 v96, 0
    v_mov_b32 v185, 0
    v_mov_b32 v97, 0
    v_mov_b32 v186, 0
    v_mov_b32 v98, 0
    v_mov_b32 v187, 0
    v_mov_b32 v99, 0
    v_mov_b32 v188, 0
    v_mov_b32 v100, 0
    v_mov_b32 v189, 0
    v_mov_b32 v101, 0
    v_mov_b32 v190, 0
    v_mov_b32 v102, 0
    v_mov_b32 v191, 0
    v_mov_b32 v103, 0
    s_mul_i32 s10, s77, 23
    s_lshr_b32 s10, s10, 6
    s_mul_i32 s11, s77, 46
    s_lshr_b32 s11, s11, 6
    s_mov_b32 s12, 0
    s_mov_b32 s13, s72
    s_cmp_ge_u32 s10, s73
    s_cselect_b32 s12, 1, s12
    s_cselect_b32 s13, s73, s13
    s_cmp_ge_u32 s10, s74
    s_cselect_b32 s12, 2, s12
    s_cselect_b32 s13, s74, s13
    s_cmp_ge_u32 s10, s75
    s_cselect_b32 s12, 3, s12
    s_cselect_b32 s13, s75, s13
    s_cmp_ge_u32 s10, s76
    s_cselect_b32 s12, 4, s12
    s_cselect_b32 s13, s76, s13
    s_cmp_lt_u32 s10, s11
    s_cselect_b32 s12, s12, 15
    s_cmp_gt_u32 s10, s13
    s_cselect_b32 s32, s12, 15
    s_mul_i32 s10, s77, 46
    s_lshr_b32 s10, s10, 6
    s_mul_i32 s11, s77, 55
    s_lshr_b32 s11, s11, 6
    s_mov_b32 s12, 0
    s_mov_b32 s13, s72
    s_cmp_ge_u32 s10, s73
    s_cselect_b32 s12, 1, s12
    s_cselect_b32 s13, s73, s13
    s_cmp_ge_u32 s10, s74
    s_cselect_b32 s12, 2, s12
    s_cselect_b32 s13, s74, s13
    s_cmp_ge_u32 s10, s75
    s_cselect_b32 s12, 3, s12
    s_cselect_b32 s13, s75, s13
    s_cmp_ge_u32 s10, s76
    s_cselect_b32 s12, 4, s12
    s_cselect_b32 s13, s76, s13
    s_cmp_lt_u32 s10, s11
    s_cselect_b32 s12, s12, 15
    s_cmp_gt_u32 s10, s13
    s_cselect_b32 s33, s12, 15
    s_mul_i32 s10, s77, 55
    s_lshr_b32 s10, s10, 6
    s_mul_i32 s11, s77, 64
    s_lshr_b32 s11, s11, 6
    s_mov_b32 s12, 0
    s_mov_b32 s13, s72
    s_cmp_ge_u32 s10, s73
    s_cselect_b32 s12, 1, s12
    s_cselect_b32 s13, s73, s13
    s_cmp_ge_u32 s10, s74
    s_cselect_b32 s12, 2, s12
    s_cselect_b32 s13, s74, s13
    s_cmp_ge_u32 s10, s75
    s_cselect_b32 s12, 3, s12
    s_cselect_b32 s13, s75, s13
    s_cmp_ge_u32 s10, s76
    s_cselect_b32 s12, 4, s12
    s_cselect_b32 s13, s76, s13
    s_cmp_lt_u32 s10, s11
    s_cselect_b32 s12, s12, 15
    s_cmp_gt_u32 s10, s13
    s_cselect_b32 s34, s12, 15
    s_waitcnt vmcnt(9) lgkmcnt(0)
    s_cmp_eq_u32 s15, 0
    s_cbranch_scc0 k2_wxdone
    s_mov_b32 s15, 1
    s_mov_b32 s89, 0xbf317218
    v_lshlrev_b32 v224, 16, v224
    v_mul_f32 v224, s89, v224
    v_lshlrev_b32 v225, 16, v225
    v_mul_f32 v225, s89, v225
    v_lshlrev_b32 v226, 16, v226
    v_mul_f32 v226, s89, v226
    v_lshlrev_b32 v227, 16, v227
    v_mul_f32 v227, s89, v227
k2_wxdone:
    v_and_b32 v15, 1, v113
    v_lshlrev_b32 v15, 4, v15
    v_alignbit_b32 v80, v115, v114, v15
    v_lshrrev_b32 v81, v15, v115
    v_lshlrev_b32 v82, 16, v80
    v_and_b32 v83, 0xffff0000, v80
    v_lshlrev_b32 v84, 16, v81
    v_lshlrev_b32 v85, 16, v116
    v_and_b32 v86, 0xffff0000, v116
    v_lshlrev_b32 v87, 16, v117
    v_sub_f32 v82, v85, v82
    v_sub_f32 v83, v86, v83
    v_sub_f32 v84, v87, v84
    v_cvt_pk_bf16_f32 v80, v82, v83
    v_cvt_pk_bf16_f32 v81, v84, v7
    v_lshlrev_b32 v82, 16, v80
    v_and_b32 v83, 0xffff0000, v80
    v_lshlrev_b32 v84, 16, v81
    v_mul_f32 v82, v82, v82
    v_mul_f32 v83, v83, v83
    v_mul_f32 v84, v84, v84
    v_cvt_pk_bf16_f32 v85, v82, v83
    v_cvt_pk_bf16_f32 v86, v84, v7
    v_lshlrev_b32 v82, 16, v85
    v_and_b32 v83, 0xffff0000, v85
    v_lshlrev_b32 v84, 16, v86
    v_add_f32 v82, v82, v83
    v_add_f32 v82, v82, v84
    v_cvt_pk_bf16_f32 v82, v82, v7
    v_and_b32 v83, 0xffff, v80
    v_lshl_or_b32 v83, v82, 16, v83
    v_alignbit_b32 v84, v81, v80, 16
    v_bfe_u32 v85, v113, 14, 3
    v_or_b32 v85, 0x80, v85
    v_cmp_le_i32 vcc, 0, v113
    s_nop 1
    v_cndmask_b32 v83, 0, v83, vcc
    v_cndmask_b32 v84, 0, v84, vcc
    v_cndmask_b32 v85, 0, v85, vcc
    ds_write_b32 v112, v83
    ds_write_b32 v112, v84 offset:3968
    v_subrev_u32 v15, 99072, v112
    v_lshrrev_b32 v15, 2, v15
    v_add_u32 v15, 107008, v15
    ds_write_b8 v15, v85
    s_cmp_eq_u32 s3, 7
    s_cbranch_scc1 k2_nogeo
    v_and_b32 v15, 1, v121
    v_lshlrev_b32 v15, 4, v15
    v_alignbit_b32 v80, v123, v122, v15
    v_lshrrev_b32 v81, v15, v123
    v_lshlrev_b32 v82, 16, v80
    v_and_b32 v83, 0xffff0000, v80
    v_lshlrev_b32 v84, 16, v81
    v_lshlrev_b32 v85, 16, v124
    v_and_b32 v86, 0xffff0000, v124
    v_lshlrev_b32 v87, 16, v125
    v_sub_f32 v82, v85, v82
    v_sub_f32 v83, v86, v83
    v_sub_f32 v84, v87, v84
    v_cvt_pk_bf16_f32 v80, v82, v83
    v_cvt_pk_bf16_f32 v81, v84, v7
    v_lshlrev_b32 v82, 16, v80
    v_and_b32 v83, 0xffff0000, v80
    v_lshlrev_b32 v84, 16, v81
    v_mul_f32 v82, v82, v82
    v_mul_f32 v83, v83, v83
    v_mul_f32 v84, v84, v84
    v_cvt_pk_bf16_f32 v85, v82, v83
    v_cvt_pk_bf16_f32 v86, v84, v7
    v_lshlrev_b32 v82, 16, v85
    v_and_b32 v83, 0xffff0000, v85
    v_lshlrev_b32 v84, 16, v86
    v_add_f32 v82, v82, v83
    v_add_f32 v82, v82, v84
    v_cvt_pk_bf16_f32 v82, v82, v7
    v_and_b32 v83, 0xffff, v80
    v_lshl_or_b32 v83, v82, 16, v83
    v_alignbit_b32 v84, v81, v80, 16
    v_bfe_u32 v85, v121, 14, 3
    v_or_b32 v85, 0x80, v85
    v_cmp_le_i32 vcc, 0, v121
    s_nop 1
    v_cndmask_b32 v83, 0, v83, vcc
    v_cndmask_b32 v84, 0, v84, vcc
    v_cndmask_b32 v85, 0, v85, vcc
    ds_write_b32 v120, v83
    ds_write_b32 v120, v84 offset:3968
    v_subrev_u32 v15, 99072, v120
    v_lshrrev_b32 v15, 2, v15
    v_add_u32 v15, 107008, v15
    ds_write_b8 v15, v85
k2_nogeo:
    s_cmp_eq_u32 s3, 7
    s_cbranch_scc0 k2_nopad
    v_lshlrev_b32 v15, 2, v1
    v_add_u32 v15, 102912, v15
    s_mov_b32 exec_hi, 0
    ds_write_b32 v15, v7
    ds_write_b32 v15, v7 offset:3968
    v_add_u32 v15, 107968, v1
    ds_write_b8 v15, v7
    s_mov_b32 exec_hi, -1
k2_nopad:
    s_waitcnt lgkmcnt(0)
    s_barrier
    s_bitcmp1_b32 s78, 20
    s_cbranch_scc0 k2_edge_done
    s_waitcnt vmcnt(0)
    s_and_b32 s89, s78, 0x3ff
    s_lshl_b32 s88, s89, 2
    v_add_u32 v11, s88, v243
    ds_read_b32 v218, v11
    ds_read_b32 v219, v11 offset:3968
    v_add_u32 v13, s89, v244
    ds_read_u8 v220, v13
    ds_read_b128 v[112:115], v5 offset:0
    ds_read_b128 v[116:119], v5 offset:32
    ds_read_b128 v[120:123], v5 offset:64
    ds_read_b128 v[124:127], v5 offset:96
    ds_read_b128 v[128:131], v5 offset:128
    ds_read_b128 v[132:135], v5 offset:160
    ds_read_b128 v[136:139], v5 offset:192
    ds_read_b128 v[140:143], v5 offset:224
    s_bfe_u32 s88, s78, 0x30010
    s_lshl_b32 s88, s88, 12
    v_add_u32 v10, s88, v9
    s_mov_b32 exec_hi, 0
    ds_read_b128 v[160:163], v10 offset:0
    ds_read_b128 v[164:167], v10 offset:512
    ds_read_b128 v[168:171], v10 offset:1024
    ds_read_b128 v[172:175], v10 offset:1536
    s_mov_b32 exec_hi, -1
    s_waitcnt lgkmcnt(12)
    v_and_b32 v10, 0x80, v220
    v_mul_u32_u24 v10, 0x7f, v10
    v_lshl_or_b32 v10, v218, 16, v10
    v_cndmask_b32 v216, v10, v219, s[64:65]
    v_and_b32 v11, 7, v220
    v_lshl_add_u32 v14, v11, 6, v3
    v_lshl_add_u32 v11, v11, 4, v247
    v_cndmask_b32 v217, v11, v248, s[64:65]
    v_lshrrev_b32 v11, 16, v218
    v_cndmask_b32 v222, 0, v11, s[64:65]
    ds_read_b128 v[196:199], v8
    ds_read_b128 v[192:195], v217
    s_waitcnt lgkmcnt(0)
    s_and_b32 s88, s94, 0x3ff
    s_lshl_b32 s88, s88, 2
    v_add_u32 v10, s88, v2
    ds_read_b128 v[208:211], v10
    ds_read_b128 v[212:215], v10 offset:16
    v_add_u32 v12, s88, v242
    ds_read_b32 v221, v12
    v_or_b32 v192, v192, v222
    v_mfma_f32_32x32x16_bf16 v[80:95], v[112:115], v[176:179], 0
    s_waitcnt lgkmcnt(0)
    s_bitcmp1_b32 s94, 20
    s_cbranch_scc0 k2_p_nodma
    s_mov_b32 m0, s39
    v_lshl_add_u32 v11, v221, 5, v245
    buffer_load_dwordx4 v11, s[48:51], 0 offen lds
    s_add_u32 m0, s87, 0
    v_add_u32 v208, v6, v208
    buffer_load_dwordx4 v208, s[44:47], s86 offen lds
    s_add_u32 m0, s87, 1040
    v_add_u32 v209, v6, v209
    buffer_load_dwordx4 v209, s[44:47], s86 offen lds
    s_add_u32 m0, s87, 2080
    v_add_u32 v210, v6, v210
    buffer_load_dwordx4 v210, s[44:47], s86 offen lds
    s_add_u32 m0, s87, 3120
    v_add_u32 v211, v6, v211
    buffer_load_dwordx4 v211, s[44:47], s86 offen lds
    s_add_u32 m0, s87, 4160
    v_add_u32 v212, v6, v212
    buffer_load_dwordx4 v212, s[44:47], s86 offen lds
    s_add_u32 m0, s87, 5200
    v_add_u32 v213, v6, v213
    buffer_load_dwordx4 v213, s[44:47], s86 offen lds
    s_add_u32 m0, s87, 6240
    v_add_u32 v214, v6, v214
    buffer_load_dwordx4 v214, s[44:47], s86 offen lds
    s_add_u32 m0, s87, 7280
    v_add_u32 v215, v6, v215
    buffer_load_dwordx4 v215, s[44:47], s86 offen lds
k2_p_nodma:
    v_mfma_f32_32x32x16_bf16 v[80:95], v[116:119], v[180:183], v[80:95]
    v_mfma_f32_32x32x16_bf16 v[80:95], v[196:199], v[144:147], v[80:95]
    v_mfma_f32_32x32x16_bf16 v[80:95], v[192:195], v[160:163], v[80:95]
    s_mov_b32 s13, 0
    s_mov_b32 s14, 0
    s_mov_b32 s12, 0
k2_grp:
    s_bitcmp1_b32 s78, 21
    s_cbranch_scc0 k2_gen
    s_nop 6
    v_exp_f32 v200, v80
    v_mfma_f32_32x32x16_bf16 v[64:79], v[184:187], v[96:99], v[64:79]
    v_exp_f32 v201, v81
    v_exp_f32 v202, v82
    v_exp_f32 v203, v83
    v_add_f32 v200, 1.0, v200
    v_add_f32 v201, 1.0, v201
    v_add_f32 v202, 1.0, v202
    v_add_f32 v203, 1.0, v203
    v_rcp_f32 v200, v200
    v_mfma_f32_32x32x16_bf16 v[64:79], v[188:191], v[100:103], v[64:79]
    v_rcp_f32 v201, v201
    v_rcp_f32 v202, v202
    v_rcp_f32 v203, v203
    v_pk_mul_f32 v[80:81], v[80:81], v[200:201]
    v_pk_mul_f32 v[82:83], v[82:83], v[202:203]
    v_cvt_pk_bf16_f32 v80, v80, v81
    v_cvt_pk_bf16_f32 v81, v82, v83
    ds_write_b16 v14, v216
    ds_write_b16_d16_hi v14, v216 offset:16
    ds_read_b128 v[184:187], v4
    ds_read_b128 v[188:191], v4 offset:1024
    ds_write_b16 v14, v7
    ds_write_b16 v14, v7 offset:16
    v_exp_f32 v204, v84
    v_mfma_f32_32x32x16_bf16 v[96:111], v[120:123], v[176:179], 0
    v_exp_f32 v205, v85
    v_exp_f32 v206, v86
    v_exp_f32 v207, v87
    v_add_f32 v204, 1.0, v204
    v_add_f32 v205, 1.0, v205
    v_add_f32 v206, 1.0, v206
    v_add_f32 v207, 1.0, v207
    v_rcp_f32 v204, v204
    v_mfma_f32_32x32x16_bf16 v[96:111], v[124:127], v[180:183], v[96:111]
    v_rcp_f32 v205, v205
    v_rcp_f32 v206, v206
    v_rcp_f32 v207, v207
    v_pk_mul_f32 v[84:85], v[84:85], v[204:205]
    v_pk_mul_f32 v[86:87], v[86:87], v[206:207]
    v_cvt_pk_bf16_f32 v82, v84, v85
    v_cvt_pk_bf16_f32 v83, v86, v87
    v_exp_f32 v200, v88
    v_mfma_f32_32x32x16_bf16 v[96:111], v[196:199], v[148:151], v[96:111]
    v_exp_f32 v201, v89
    v_exp_f32 v202, v90
    v_exp_f32 v203, v91
    v_add_f32 v200, 1.0, v200
    v_add_f32 v201, 1.0, v201
    v_add_f32 v202, 1.0, v202
    v_add_f32 v203, 1.0, v203
    v_rcp_f32 v200, v200
    v_rcp_f32 v201, v201
    v_rcp_f32 v202, v202
    v_rcp_f32 v203, v203
    v_pk_mul_f32 v[88:89], v[88:89], v[200:201]
    v_pk_mul_f32 v[90:91], v[90:91], v[202:203]
    v_cvt_pk_bf16_f32 v84, v88, v89
    v_cvt_pk_bf16_f32 v85, v90, v91
    v_exp_f32 v204, v92
    v_mfma_f32_32x32x16_bf16 v[96:111], v[192:195], v[164:167], v[96:111]
    v_exp_f32 v205, v93
    v_exp_f32 v206, v94
    v_exp_f32 v207, v95
    v_add_f32 v204, 1.0, v204
    v_add_f32 v205, 1.0, v205
    v_add_f32 v206, 1.0, v206
    v_add_f32 v207, 1.0, v207
    v_rcp_f32 v204, v204
    v_rcp_f32 v205, v205
    v_rcp_f32 v206, v206
    v_rcp_f32 v207, v207
    v_pk_mul_f32 v[92:93], v[92:93], v[204:205]
    v_pk_mul_f32 v[94:95], v[94:95], v[206:207]
    v_cvt_pk_bf16_f32 v86, v92, v93
    v_cvt_pk_bf16_f32 v87, v94, v95
    s_bitcmp1_b32 s13, 19
    s_cbranch_scc1 k2_flush
k2_noflf:
    s_waitcnt lgkmcnt(0)
    v_exp_f32 v200, v96
    v_mfma_f32_32x32x16_bf16 v[16:31], v[184:187], v[80:83], v[16:31]
    v_exp_f32 v201, v97
    v_exp_f32 v202, v98
    v_exp_f32 v203, v99
    v_add_f32 v200, 1.0, v200
    v_add_f32 v201, 1.0, v201
    v_add_f32 v202, 1.0, v202
    v_add_f32 v203, 1.0, v203
    v_rcp_f32 v200, v200
    v_mfma_f32_32x32x16_bf16 v[16:31], v[188:191], v[84:87], v[16:31]
    v_rcp_f32 v201, v201
    v_rcp_f32 v202, v202
    v_rcp_f32 v203, v203
    v_pk_mul_f32 v[96:97], v[96:97], v[200:201]
    v_pk_mul_f32 v[98:99], v[98:99], v[202:203]
    v_cvt_pk_bf16_f32 v96, v96, v97
    v_cvt_pk_bf16_f32 v97, v98, v99
    s_and_b32 s89, s94, 0x3ff
    s_lshl_b32 s88, s89, 2
    v_add_u32 v11, s88, v243
    ds_read_b32 v218, v11
    ds_read_b32 v219, v11 offset:3968
    v_add_u32 v13, s89, v244
    ds_read_u8 v220, v13
    v_exp_f32 v204, v100
    v_mfma_f32_32x32x16_bf16 v[80:95], v[128:131], v[176:179], 0
    v_exp_f32 v205, v101
    v_exp_f32 v206, v102
    v_exp_f32 v207, v103
    v_add_f32 v204, 1.0, v204
    v_add_f32 v205, 1.0, v205
    v_add_f32 v206, 1.0, v206
    v_add_f32 v207, 1.0, v207
    v_rcp_f32 v204, v204
    v_mfma_f32_32x32x16_bf16 v[80:95], v[132:135], v[180:183], v[80:95]
    v_rcp_f32 v205, v205
    v_rcp_f32 v206, v206
    v_rcp_f32 v207, v207
    v_pk_mul_f32 v[100:101], v[100:101], v[204:205]
    v_pk_mul_f32 v[102:103], v[102:103], v[206:207]
    v_cvt_pk_bf16_f32 v98, v100, v101
    v_cvt_pk_bf16_f32 v99, v102, v103
    v_exp_f32 v200, v104
    v_mfma_f32_32x32x16_bf16 v[80:95], v[196:199], v[152:155], v[80:95]
    v_exp_f32 v201, v105
    v_exp_f32 v202, v106
    v_exp_f32 v203, v107
    v_add_f32 v200, 1.0, v200
    v_add_f32 v201, 1.0, v201
    v_add_f32 v202, 1.0, v202
    v_add_f32 v203, 1.0, v203
    v_rcp_f32 v200, v200
    v_rcp_f32 v201, v201
    v_rcp_f32 v202, v202
    v_rcp_f32 v203, v203
    v_pk_mul_f32 v[104:105], v[104:105], v[200:201]
    v_pk_mul_f32 v[106:107], v[106:107], v[202:203]
    v_cvt_pk_bf16_f32 v100, v104, v105
    v_cvt_pk_bf16_f32 v101, v106, v107
    v_exp_f32 v204, v108
    v_mfma_f32_32x32x16_bf16 v[80:95], v[192:195], v[168:171], v[80:95]
    v_exp_f32 v205, v109
    v_exp_f32 v206, v110
    v_exp_f32 v207, v111
    v_add_f32 v204, 1.0, v204
    v_add_f32 v205, 1.0, v205
    v_add_f32 v206, 1.0, v206
    v_add_f32 v207, 1.0, v207
    v_rcp_f32 v204, v204
    v_rcp_f32 v205, v205
    v_rcp_f32 v206, v206
    v_rcp_f32 v207, v207
    v_pk_mul_f32 v[108:109], v[108:109], v[204:205]
    v_pk_mul_f32 v[110:111], v[110:111], v[206:207]
    v_cvt_pk_bf16_f32 v102, v108, v109
    v_cvt_pk_bf16_f32 v103, v110, v111
    v_exp_f32 v200, v80
    v_mfma_f32_32x32x16_bf16 v[32:47], v[184:187], v[96:99], v[32:47]
    v_exp_f32 v201, v81
    v_exp_f32 v202, v82
    v_exp_f32 v203, v83
    v_add_f32 v200, 1.0, v200
    v_add_f32 v201, 1.0, v201
    v_add_f32 v202, 1.0, v202
    v_add_f32 v203, 1.0, v203
    v_rcp_f32 v200, v200
    v_mfma_f32_32x32x16_bf16 v[32:47], v[188:191], v[100:103], v[32:47]
    v_rcp_f32 v201, v201
    v_rcp_f32 v202, v202
    v_rcp_f32 v203, v203
    v_pk_mul_f32 v[80:81], v[80:81], v[200:201]
    v_pk_mul_f32 v[82:83], v[82:83], v[202:203]
    v_cvt_pk_bf16_f32 v80, v80, v81
    v_cvt_pk_bf16_f32 v81, v82, v83
    v_exp_f32 v204, v84
    v_mfma_f32_32x32x16_bf16 v[96:111], v[136:139], v[176:179], 0
    v_exp_f32 v205, v85
    v_exp_f32 v206, v86
    v_exp_f32 v207, v87
    v_add_f32 v204, 1.0, v204
    v_add_f32 v205, 1.0, v205
    v_add_f32 v206, 1.0, v206
    v_add_f32 v207, 1.0, v207
    v_rcp_f32 v204, v204
    v_mfma_f32_32x32x16_bf16 v[96:111], v[140:143], v[180:183], v[96:111]
    v_rcp_f32 v205, v205
    v_rcp_f32 v206, v206
    v_rcp_f32 v207, v207
    v_pk_mul_f32 v[84:85], v[84:85], v[204:205]
    v_pk_mul_f32 v[86:87], v[86:87], v[206:207]
    v_cvt_pk_bf16_f32 v82, v84, v85
    v_cvt_pk_bf16_f32 v83, v86, v87
    s_waitcnt vmcnt(0) lgkmcnt(0)
    ds_read_b128 v[112:115], v5 offset:0
    ds_read_b128 v[116:119], v5 offset:32
    ds_read_b128 v[120:123], v5 offset:64
    ds_read_b128 v[124:127], v5 offset:96
    ds_read_b128 v[128:131], v5 offset:128
    ds_read_b128 v[132:135], v5 offset:160
    ds_read_b128 v[136:139], v5 offset:192
    ds_read_b128 v[140:143], v5 offset:224
    v_and_b32 v10, 0x80, v220
    v_mul_u32_u24 v10, 0x7f, v10
    v_lshl_or_b32 v10, v218, 16, v10
    v_cndmask_b32 v216, v10, v219, s[64:65]
    v_and_b32 v11, 7, v220
    v_lshl_add_u32 v14, v11, 6, v3
    v_lshl_add_u32 v11, v11, 4, v247
    v_cndmask_b32 v217, v11, v248, s[64:65]
    v_lshrrev_b32 v11, 16, v218
    v_cndmask_b32 v222, 0, v11, s[64:65]
    v_exp_f32 v200, v88
    v_mfma_f32_32x32x16_bf16 v[96:111], v[196:199], v[156:159], v[96:111]
    v_exp_f32 v201, v89
    v_exp_f32 v202, v90
    v_exp_f32 v203, v91
    v_add_f32 v200, 1.0, v200
    v_add_f32 v201, 1.0, v201
    v_add_f32 v202, 1.0, v202
    v_add_f32 v203, 1.0, v203
    v_rcp_f32 v200, v200
    v_rcp_f32 v201, v201
    v_rcp_f32 v202, v202
    v_rcp_f32 v203, v203
    v_pk_mul_f32 v[88:89], v[88:89], v[200:201]
    v_pk_mul_f32 v[90:91], v[90:91], v[202:203]
    v_cvt_pk_bf16_f32 v84, v88, v89
    v_cvt_pk_bf16_f32 v85, v90, v91
    v_exp_f32 v204, v92
    v_mfma_f32_32x32x16_bf16 v[96:111], v[192:195], v[172:175], v[96:111]
    v_exp_f32 v205, v93
    v_exp_f32 v206, v94
    v_exp_f32 v207, v95
    v_add_f32 v204, 1.0, v204
    v_add_f32 v205, 1.0, v205
    v_add_f32 v206, 1.0, v206
    v_add_f32 v207, 1.0, v207
    v_rcp_f32 v204, v204
    v_rcp_f32 v205, v205
    v_rcp_f32 v206, v206
    v_rcp_f32 v207, v207
    v_pk_mul_f32 v[92:93], v[92:93], v[204:205]
    v_pk_mul_f32 v[94:95], v[94:95], v[206:207]
    v_cvt_pk_bf16_f32 v86, v92, v93
    v_cvt_pk_bf16_f32 v87, v94, v95
    ds_read_b128 v[196:199], v8
    ds_read_b128 v[192:195], v217
    s_and_b32 s88, s6, 0x3ff
    s_lshl_b32 s88, s88, 2
    v_add_u32 v10, s88, v2
    ds_read_b128 v[208:211], v10
    ds_read_b128 v[212:215], v10 offset:16
    v_add_u32 v12, s88, v242
    ds_read_b32 v221, v12
    s_xor_b32 s88, s94, s78
    s_and_b32 s88, s88, 0x70000
    s_cbranch_scc1 k2_wdaf
k2_wdarf:
    v_exp_f32 v200, v96
    v_mfma_f32_32x32x16_bf16 v[48:63], v[184:187], v[80:83], v[48:63]
    v_exp_f32 v201, v97
    v_exp_f32 v202, v98
    v_exp_f32 v203, v99
    v_add_f32 v200, 1.0, v200
    v_add_f32 v201, 1.0, v201
    v_add_f32 v202, 1.0, v202
    v_add_f32 v203, 1.0, v203
    v_rcp_f32 v200, v200
    v_mfma_f32_32x32x16_bf16 v[48:63], v[188:191], v[84:87], v[48:63]
    v_rcp_f32 v201, v201
    v_rcp_f32 v202, v202
    v_rcp_f32 v203, v203
    v_pk_mul_f32 v[96:97], v[96:97], v[200:201]
    v_pk_mul_f32 v[98:99], v[98:99], v[202:203]
    v_cvt_pk_bf16_f32 v96, v96, v97
    v_cvt_pk_bf16_f32 v97, v98, v99
    s_waitcnt lgkmcnt(0)
    v_or_b32 v192, v192, v222
    s_bitcmp1_b32 s6, 20
    s_cbranch_scc0 k2_latef
    s_mov_b32 m0, s39
    v_lshl_add_u32 v11, v221, 5, v245
    buffer_load_dwordx4 v11, s[48:51], 0 offen lds
    s_add_u32 m0, s87, 0
    v_add_u32 v208, v6, v208
    buffer_load_dwordx4 v208, s[44:47], s86 offen lds
    s_add_u32 m0, s87, 1040
    v_add_u32 v209, v6, v209
    buffer_load_dwordx4 v209, s[44:47], s86 offen lds
    s_add_u32 m0, s87, 2080
    v_add_u32 v210, v6, v210
    buffer_load_dwordx4 v210, s[44:47], s86 offen lds
    s_add_u32 m0, s87, 3120
    v_add_u32 v211, v6, v211
    buffer_load_dwordx4 v211, s[44:47], s86 offen lds
    s_add_u32 m0, s87, 4160
    v_add_u32 v212, v6, v212
    buffer_load_dwordx4 v212, s[44:47], s86 offen lds
    s_add_u32 m0, s87, 5200
    v_add_u32 v213, v6, v213
    buffer_load_dwordx4 v213, s[44:47], s86 offen lds
    s_add_u32 m0, s87, 6240
    v_add_u32 v214, v6, v214
    buffer_load_dwordx4 v214, s[44:47], s86 offen lds
    s_add_u32 m0, s87, 7280
    v_add_u32 v215, v6, v215
    buffer_load_dwordx4 v215, s[44:47], s86 offen lds
k2_nx3f:
    v_exp_f32 v204, v100
    v_mfma_f32_32x32x16_bf16 v[80:95], v[112:115], v[176:179], 0
    v_exp_f32 v205, v101
    v_exp_f32 v206, v102
    v_exp_f32 v207, v103
    v_add_f32 v204, 1.0, v204
    v_add_f32 v205, 1.0, v205
    v_add_f32 v206, 1.0, v206
    v_add_f32 v207, 1.0, v207
    v_rcp_f32 v204, v204
    v_mfma_f32_32x32x16_bf16 v[80:95], v[116:119], v[180:183], v[80:95]
    v_rcp_f32 v205, v205
    v_rcp_f32 v206, v206
    v_rcp_f32 v207, v207
    v_pk_mul_f32 v[100:101], v[100:101], v[204:205]
    v_pk_mul_f32 v[102:103], v[102:103], v[206:207]
    v_cvt_pk_bf16_f32 v98, v100, v101
    v_cvt_pk_bf16_f32 v99, v102, v103
    v_exp_f32 v200, v104
    v_mfma_f32_32x32x16_bf16 v[80:95], v[196:199], v[144:147], v[80:95]
    v_exp_f32 v201, v105
    v_exp_f32 v202, v106
    v_exp_f32 v203, v107
    v_add_f32 v200, 1.0, v200
    v_add_f32 v201, 1.0, v201
    v_add_f32 v202, 1.0, v202
    v_add_f32 v203, 1.0, v203
    v_rcp_f32 v200, v200
    v_rcp_f32 v201, v201
    v_rcp_f32 v202, v202
    v_rcp_f32 v203, v203
    v_pk_mul_f32 v[104:105], v[104:105], v[200:201]
    v_pk_mul_f32 v[106:107], v[106:107], v[202:203]
    v_cvt_pk_bf16_f32 v100, v104, v105
    v_cvt_pk_bf16_f32 v101, v106, v107
    v_exp_f32 v204, v108
    v_mfma_f32_32x32x16_bf16 v[80:95], v[192:195], v[160:163], v[80:95]
    v_exp_f32 v205, v109
    v_exp_f32 v206, v110
    v_exp_f32 v207, v111
    v_add_f32 v204, 1.0, v204
    v_add_f32 v205, 1.0, v205
    v_add_f32 v206, 1.0, v206
    v_add_f32 v207, 1.0, v207
    v_rcp_f32 v204, v204
    v_rcp_f32 v205, v205
    v_rcp_f32 v206, v206
    v_rcp_f32 v207, v207
    v_pk_mul_f32 v[108:109], v[108:109], v[204:205]
    v_pk_mul_f32 v[110:111], v[110:111], v[206:207]
    v_cvt_pk_bf16_f32 v102, v108, v109
    v_cvt_pk_bf16_f32 v103, v110, v111
k2_rot:
    s_mov_b32 s13, s78
    s_mov_b32 s14, s38
    s_bitcmp1_b32 s78, 19
    s_cselect_b32 s38, 0, s38
    s_mov_b32 s78, s94
    s_mov_b32 s94, s6
    s_add_u32 s30, s30, 1
    v_readlane_b32 s6, v246, s30
    s_bitcmp1_b32 s78, 20
    s_cbranch_scc1 k2_grp
    v_mfma_f32_32x32x16_bf16 v[64:79], v[184:187], v[96:99], v[64:79]
    v_mfma_f32_32x32x16_bf16 v[64:79], v[188:191], v[100:103], v[64:79]
    s_bfe_u32 s91, s13, 0x30010
    v_and_b32 v10, 31, v1
    v_lshrrev_b32 v11, 5, v1
    v_lshrrev_b32 v12, 2, v10
    s_lshl_b32 s88, s5, 4
    v_add_u32 v12, s88, v12
    v_xor_b32 v12, v12, v11
    v_lshlrev_b32 v12, 4, v12
    v_lshl_add_u32 v12, v11, 9, v12
    v_and_b32 v13, 3, v10
    v_lshl_add_u32 v12, v13, 2, v12
    s_and_b32 s88, s91, 1
    s_lshl_b32 s88, s88, 7
    v_xor_b32 v12, s88, v12
    s_lshl_b32 s88, s91, 12
    s_add_u32 s88, s88, 128512
    s_lshl_b32 s89, s4, 12
    s_add_u32 s89, s89, 144896
    s_cmp_eq_u32 s14, 1
    s_cselect_b32 s88, s89, s88
    v_add_u32 v12, s88, v12
    s_mov_b32 s89, 0xbf317218
    v_mul_f32 v16, s89, v16
    v_mul_f32 v32, s89, v32
    v_mul_f32 v20, s89, v20
    v_mul_f32 v36, s89, v36
    v_mul_f32 v24, s89, v24
    v_mul_f32 v40, s89, v40
    v_mul_f32 v28, s89, v28
    v_mul_f32 v44, s89, v44
    v_mul_f32 v48, s89, v48
    v_mul_f32 v64, s89, v64
    v_mul_f32 v52, s89, v52
    v_mul_f32 v68, s89, v68
    v_mul_f32 v56, s89, v56
    v_mul_f32 v72, s89, v72
    v_mul_f32 v60, s89, v60
    v_mul_f32 v76, s89, v76
    v_xor_b32 v200, 0, v12
    v_xor_b32 v204, 128, v12
    v_xor_b32 v201, 32, v12
    v_xor_b32 v205, 160, v12
    v_xor_b32 v202, 64, v12
    v_xor_b32 v206, 192, v12
    v_xor_b32 v203, 96, v12
    v_xor_b32 v207, 224, v12
    v_cvt_pk_bf16_f32 v16, v16, v32
    v_cvt_pk_bf16_f32 v20, v20, v36
    v_cvt_pk_bf16_f32 v24, v24, v40
    v_cvt_pk_bf16_f32 v28, v28, v44
    v_cvt_pk_bf16_f32 v48, v48, v64
    v_cvt_pk_bf16_f32 v52, v52, v68
    v_cvt_pk_bf16_f32 v56, v56, v72
    v_cvt_pk_bf16_f32 v60, v60, v76
    ds_write_b32 v200, v16 offset:0
    ds_write_b32 v201, v20 offset:1024
    ds_write_b32 v202, v24 offset:2048
    ds_write_b32 v203, v28 offset:3072
    ds_write_b32 v204, v48 offset:0
    ds_write_b32 v205, v52 offset:1024
    ds_write_b32 v206, v56 offset:2048
    ds_write_b32 v207, v60 offset:3072
    v_pk_mul_f32 v[16:17], v[16:17], v[224:225] op_sel:[0,0] op_sel_hi:[1,0]
    v_pk_mul_f32 v[18:19], v[18:19], v[224:225] op_sel:[0,0] op_sel_hi:[1,0]
    v_pk_mul_f32 v[20:21], v[20:21], v[224:225] op_sel:[0,0] op_sel_hi:[1,0]
    v_pk_mul_f32 v[22:23], v[22:23], v[224:225] op_sel:[0,0] op_sel_hi:[1,0]
    v_pk_mul_f32 v[24:25], v[24:25], v[224:225] op_sel:[0,0] op_sel_hi:[1,0]
    v_pk_mul_f32 v[26:27], v[26:27], v[224:225] op_sel:[0,0] op_sel_hi:[1,0]
    v_pk_mul_f32 v[28:29], v[28:29], v[224:225] op_sel:[0,0] op_sel_hi:[1,0]
    v_pk_mul_f32 v[30:31], v[30:31], v[224:225] op_sel:[0,0] op_sel_hi:[1,0]
    v_pk_fma_f32 v[16:17], v[32:33], v[224:225], v[16:17] op_sel:[0,1,0] op_sel_hi:[1,1,1]
    v_pk_fma_f32 v[18:19], v[34:35], v[224:225], v[18:19] op_sel:[0,1,0] op_sel_hi:[1,1,1]
    v_pk_fma_f32 v[20:21], v[36:37], v[224:225], v[20:21] op_sel:[0,1,0] op_sel_hi:[1,1,1]
    v_pk_fma_f32 v[22:23], v[38:39], v[224:225], v[22:23] op_sel:[0,1,0] op_sel_hi:[1,1,1]
    v_pk_fma_f32 v[24:25], v[40:41], v[224:225], v[24:25] op_sel:[0,1,0] op_sel_hi:[1,1,1]
    v_pk_fma_f32 v[26:27], v[42:43], v[224:225], v[26:27] op_sel:[0,1,0] op_sel_hi:[1,1,1]
    v_pk_fma_f32 v[28:29], v[44:45], v[224:225], v[28:29] op_sel:[0,1,0] op_sel_hi:[1,1,1]
    v_pk_fma_f32 v[30:31], v[46:47], v[224:225], v[30:31] op_sel:[0,1,0] op_sel_hi:[1,1,1]
    v_pk_fma_f32 v[16:17], v[48:49], v[226:227], v[16:17] op_sel:[0,0,0] op_sel_hi:[1,0,1]
    v_pk_fma_f32 v[18:19], v[50:51], v[226:227], v[18:19] op_sel:[0,0,0] op_sel_hi:[1,0,1]
    v_pk_fma_f32 v[20:21], v[52:53], v[226:227], v[20:21] op_sel:[0,0,0] op_sel_hi:[1,0,1]
    v_pk_fma_f32 v[22:23], v[54:55], v[226:227], v[22:23] op_sel:[0,0,0] op_sel_hi:[1,0,1]
    v_pk_fma_f32 v[24:25], v[56:57], v[226:227], v[24:25] op_sel:[0,0,0] op_sel_hi:[1,0,1]
    v_pk_fma_f32 v[26:27], v[58:59], v[226:227], v[26:27] op_sel:[0,0,0] op_sel_hi:[1,0,1]
    v_pk_fma_f32 v[28:29], v[60:61], v[226:227], v[28:29] op_sel:[0,0,0] op_sel_hi:[1,0,1]
    v_pk_fma_f32 v[30:31], v[62:63], v[226:227], v[30:31] op_sel:[0,0,0] op_sel_hi:[1,0,1]
    v_pk_fma_f32 v[16:17], v[64:65], v[226:227], v[16:17] op_sel:[0,1,0] op_sel_hi:[1,1,1]
    v_pk_fma_f32 v[18:19], v[66:67], v[226:227], v[18:19] op_sel:[0,1,0] op_sel_hi:[1,1,1]
    v_pk_fma_f32 v[20:21], v[68:69], v[226:227], v[20:21] op_sel:[0,1,0] op_sel_hi:[1,1,1]
    v_pk_fma_f32 v[22:23], v[70:71], v[226:227], v[22:23] op_sel:[0,1,0] op_sel_hi:[1,1,1]
    v_pk_fma_f32 v[24:25], v[72:73], v[226:227], v[24:25] op_sel:[0,1,0] op_sel_hi:[1,1,1]
    v_pk_fma_f32 v[26:27], v[74:75], v[226:227], v[26:27] op_sel:[0,1,0] op_sel_hi:[1,1,1]
    v_pk_fma_f32 v[28:29], v[76:77], v[226:227], v[28:29] op_sel:[0,1,0] op_sel_hi:[1,1,1]
    v_pk_fma_f32 v[30:31], v[78:79], v[226:227], v[30:31] op_sel:[0,1,0] op_sel_hi:[1,1,1]
    v_permlane16_swap_b32 v17, v18
    v_permlane16_swap_b32 v19, v21
    v_permlane16_swap_b32 v22, v23
    v_permlane16_swap_b32 v25, v26
    v_permlane16_swap_b32 v27, v29
    v_permlane16_swap_b32 v30, v31
    v_add_f32 v17, v17, v18
    v_add_f32 v19, v19, v21
    v_add_f32 v22, v22, v23
    v_add_f32 v25, v25, v26
    v_add_f32 v27, v27, v29
    v_add_f32 v30, v30, v31
    v_add_f32_dpp v18, v17, v17 row_ror:8 row_mask:0xf bank_mask:0x3
    v_add_f32_dpp v21, v22, v22 row_ror:8 row_mask:0xf bank_mask:0x3
    v_add_f32_dpp v23, v27, v27 row_ror:8 row_mask:0xf bank_mask:0x3
    v_add_f32_dpp v18, v19, v19 row_ror:8 row_mask:0xf bank_mask:0xc
    v_add_f32_dpp v21, v25, v25 row_ror:8 row_mask:0xf bank_mask:0xc
    v_add_f32_dpp v23, v30, v30 row_ror:8 row_mask:0xf bank_mask:0xc
    v_add_f32_dpp v26, v18, v18 row_half_mirror row_mask:0xf bank_mask:0x5
    s_nop 0
    v_add_f32_dpp v29, v23, v23 row_half_mirror row_mask:0xf bank_mask:0xf
    v_add_f32_dpp v26, v21, v21 row_half_mirror row_mask:0xf bank_mask:0xa
    s_nop 1
    v_add_f32_dpp v26, v26, v26 quad_perm:[1,0,3,2] row_mask:0xf bank_mask:0xf
    v_add_f32_dpp v29, v29, v29 quad_perm:[1,0,3,2] row_mask:0xf bank_mask:0xf
    s_nop 0
    v_add_f32_dpp v26, v26, v26 quad_perm:[2,3,0,1] row_mask:0xf bank_mask:0xf
    v_add_f32_dpp v29, v29, v29 quad_perm:[2,3,0,1] row_mask:0xf bank_mask:0xf
    s_mul_i32 s88, s91, 192
    s_add_u32 s88, s88, 161280
    s_mul_i32 s89, s4, 192
    s_add_u32 s89, s89, 162048
    s_cmp_eq_u32 s14, 1
    s_cselect_b32 s88, s89, s88
    s_mul_i32 s89, s5, 96
    s_add_u32 s88, s88, s89
    v_add_u32 v12, s88, v240
    v_add_u32 v13, s88, v241
    s_mov_b32 exec_lo, 0x11111111
    s_mov_b32 exec_hi, 0x11111111
    ds_write_b32 v12, v26
    s_mov_b32 exec_lo, 0x01010101
    s_mov_b32 exec_hi, 0x01010101
    ds_write_b32 v13, v29
    s_mov_b64 exec, -1
    s_branch k2_edge_done2
k2_edge_done:
    v_lshrrev_b32 v13, 5, v1
    s_mul_i32 s89, s3, 6
    v_add_u32 v13, s89, v13
    v_and_b32 v10, 31, v1
    s_mul_i32 s90, s2, 40
    v_and_b32 v11, 15, v13
    v_xor_b32 v11, v11, v10
    v_lshlrev_b32 v11, 4, v11
    v_add_u32 v12, s90, v13
    v_lshl_add_u32 v11, v12, 9, v11
    s_and_b32 s91, s3, 1
    s_lshl_b32 s91, s91, 7
    s_add_u32 s91, s91, s87
    s_add_u32 m0, s91, 0
    s_nop 0
    buffer_load_dwordx4 v11, s[56:59], 0 offen lds
    v_add_u32 v13, 2, v13
    v_and_b32 v11, 15, v13
    v_xor_b32 v11, v11, v10
    v_lshlrev_b32 v11, 4, v11
    v_add_u32 v12, s90, v13
    v_lshl_add_u32 v11, v12, 9, v11
    s_and_b32 s91, s3, 1
    s_lshl_b32 s91, s91, 7
    s_add_u32 s91, s91, s87
    s_add_u32 m0, s91, 1024
    s_nop 0
    buffer_load_dwordx4 v11, s[56:59], 0 offen lds
    v_add_u32 v13, 2, v13
    v_and_b32 v11, 15, v13
    v_xor_b32 v11, v11, v10
    v_lshlrev_b32 v11, 4, v11
    v_add_u32 v12, s90, v13
    v_lshl_add_u32 v11, v12, 9, v11
    s_and_b32 s91, s3, 1
    s_lshl_b32 s91, s91, 7
    s_add_u32 s91, s91, s87
    s_add_u32 m0, s91, 2048
    s_nop 0
    buffer_load_dwordx4 v11, s[56:59], 0 offen lds
    v_lshlrev_b32 v12, 4, v1
    s_lshl_b32 s88, s3, 15
    s_add_u32 s88, s88, 16121856
    s_add_u32 s89, s88, 0
    buffer_load_dwordx4 v[112:115], v12, s[40:43], s89 offen
    s_add_u32 s89, s88, 1024
    buffer_load_dwordx4 v[116:119], v12, s[40:43], s89 offen
    s_add_u32 s89, s88, 2048
    buffer_load_dwordx4 v[120:123], v12, s[40:43], s89 offen
    s_add_u32 s89, s88, 3072
    buffer_load_dwordx4 v[124:127], v12, s[40:43], s89 offen
    s_add_u32 s89, s88, 4096
    buffer_load_dwordx4 v[128:131], v12, s[40:43], s89 offen
    s_add_u32 s89, s88, 5120
    buffer_load_dwordx4 v[132:135], v12, s[40:43], s89 offen
    s_add_u32 s89, s88, 6144
    buffer_load_dwordx4 v[136:139], v12, s[40:43], s89 offen
    s_add_u32 s89, s88, 7168
    buffer_load_dwordx4 v[140:143], v12, s[40:43], s89 offen
    s_add_u32 s89, s88, 8192
    buffer_load_dwordx4 v[144:147], v12, s[40:43], s89 offen
    s_add_u32 s89, s88, 9216
    buffer_load_dwordx4 v[148:151], v12, s[40:43], s89 offen
    s_add_u32 s89, s88, 10240
    buffer_load_dwordx4 v[152:155], v12, s[40:43], s89 offen
    s_add_u32 s89, s88, 11264
    buffer_load_dwordx4 v[156:159], v12, s[40:43], s89 offen
    s_add_u32 s89, s88, 12288
    buffer_load_dwordx4 v[160:163], v12, s[40:43], s89 offen
    s_add_u32 s89, s88, 13312
    buffer_load_dwordx4 v[164:167], v12, s[40:43], s89 offen
    s_add_u32 s89, s88, 14336
    buffer_load_dwordx4 v[168:171], v12, s[40:43], s89 offen
    s_add_u32 s89, s88, 15360
    buffer_load_dwordx4 v[172:175], v12, s[40:43], s89 offen
k2_edge_done2:
    v_lshlrev_b32 v12, 4, v1
    s_lshl_b32 s88, s3, 15
    s_add_u32 s88, s88, 16138240
    s_add_u32 s89, s88, 0
    buffer_load_dwordx4 v[16:19], v12, s[40:43], s89 offen
    s_add_u32 s89, s88, 1024
    buffer_load_dwordx4 v[20:23], v12, s[40:43], s89 offen
    s_add_u32 s89, s88, 2048
    buffer_load_dwordx4 v[24:27], v12, s[40:43], s89 offen
    s_add_u32 s89, s88, 3072
    buffer_load_dwordx4 v[28:31], v12, s[40:43], s89 offen
    s_add_u32 s89, s88, 4096
    buffer_load_dwordx4 v[32:35], v12, s[40:43], s89 offen
    s_add_u32 s89, s88, 5120
    buffer_load_dwordx4 v[36:39], v12, s[40:43], s89 offen
    s_add_u32 s89, s88, 6144
    buffer_load_dwordx4 v[40:43], v12, s[40:43], s89 offen
    s_add_u32 s89, s88, 7168
    buffer_load_dwordx4 v[44:47], v12, s[40:43], s89 offen
    s_add_u32 s89, s88, 8192
    buffer_load_dwordx4 v[48:51], v12, s[40:43], s89 offen
    s_add_u32 s89, s88, 9216
    buffer_load_dwordx4 v[52:55], v12, s[40:43], s89 offen
    s_add_u32 s89, s88, 10240
    buffer_load_dwordx4 v[56:59], v12, s[40:43], s89 offen
    s_add_u32 s89, s88, 11264
    buffer_load_dwordx4 v[60:63], v12, s[40:43], s89 offen
    s_add_u32 s89, s88, 12288
    buffer_load_dwordx4 v[64:67], v12, s[40:43], s89 offen
    s_add_u32 s89, s88, 13312
    buffer_load_dwordx4 v[68:71], v12, s[40:43], s89 offen
    s_add_u32 s89, s88, 14336
    buffer_load_dwordx4 v[72:75], v12, s[40:43], s89 offen
    s_add_u32 s89, s88, 15360
    buffer_load_dwordx4 v[76:79], v12, s[40:43], s89 offen
    s_waitcnt vmcnt(32) lgkmcnt(0)
    s_barrier
    s_mov_b32 s7, s32
    s_mov_b32 s8, s33
    s_mov_b32 s9, s34
    v_lshlrev_b32 v176, 3, v0
    s_cmp_eq_u32 s7, 15
    s_cbranch_scc1 k2_mg1
    s_lshl_b32 s11, s7, 12
    s_add_u32 s11, s11, 128512
    v_add_u32 v177, s11, v176
    v_add_u32 v178, 148992, v176
    ds_read_b64 v[180:181], v177
    ds_read_b64 v[182:183], v178
    s_waitcnt lgkmcnt(0)
    v_lshlrev_b32 v184, 16, v180
    v_lshlrev_b32 v185, 16, v182
    v_add_f32 v184, v184, v185
    v_and_b32 v186, 0xffff0000, v180
    v_and_b32 v187, 0xffff0000, v182
    v_add_f32 v186, v186, v187
    v_cvt_pk_bf16_f32 v180, v184, v186
    v_lshlrev_b32 v184, 16, v181
    v_lshlrev_b32 v185, 16, v183
    v_add_f32 v184, v184, v185
    v_and_b32 v186, 0xffff0000, v181
    v_and_b32 v187, 0xffff0000, v183
    v_add_f32 v186, v186, v187
    v_cvt_pk_bf16_f32 v181, v184, v186
    ds_write_b64 v177, v[180:181]
k2_mg1:
    s_cmp_eq_u32 s8, 15
    s_cbranch_scc1 k2_mg2
    s_lshl_b32 s11, s8, 12
    s_add_u32 s11, s11, 128512
    v_add_u32 v177, s11, v176
    v_add_u32 v178, 153088, v176
    ds_read_b64 v[180:181], v177
    ds_read_b64 v[182:183], v178
    s_waitcnt lgkmcnt(0)
    v_lshlrev_b32 v184, 16, v180
    v_lshlrev_b32 v185, 16, v182
    v_add_f32 v184, v184, v185
    v_and_b32 v186, 0xffff0000, v180
    v_and_b32 v187, 0xffff0000, v182
    v_add_f32 v186, v186, v187
    v_cvt_pk_bf16_f32 v180, v184, v186
    v_lshlrev_b32 v184, 16, v181
    v_lshlrev_b32 v185, 16, v183
    v_add_f32 v184, v184, v185
    v_and_b32 v186, 0xffff0000, v181
    v_and_b32 v187, 0xffff0000, v183
    v_add_f32 v186, v186, v187
    v_cvt_pk_bf16_f32 v181, v184, v186
    ds_write_b64 v177, v[180:181]
k2_mg2:
    s_cmp_eq_u32 s9, 15
    s_cbranch_scc1 k2_mg3
    s_lshl_b32 s11, s9, 12
    s_add_u32 s11, s11, 128512
    v_add_u32 v177, s11, v176
    v_add_u32 v178, 157184, v176
    ds_read_b64 v[180:181], v177
    ds_read_b64 v[182:183], v178
    s_waitcnt lgkmcnt(0)
    v_lshlrev_b32 v184, 16, v180
    v_lshlrev_b32 v185, 16, v182
    v_add_f32 v184, v184, v185
    v_and_b32 v186, 0xffff0000, v180
    v_and_b32 v187, 0xffff0000, v182
    v_add_f32 v186, v186, v187
    v_cvt_pk_bf16_f32 v180, v184, v186
    v_lshlrev_b32 v184, 16, v181
    v_lshlrev_b32 v185, 16, v183
    v_add_f32 v184, v184, v185
    v_and_b32 v186, 0xffff0000, v181
    v_and_b32 v187, 0xffff0000, v183
    v_add_f32 v186, v186, v187
    v_cvt_pk_bf16_f32 v181, v184, v186
    ds_write_b64 v177, v[180:181]
k2_mg3:
    s_cmp_eq_u32 s22, 0
    s_cbranch_scc0 k2_nz0
    v_add_u32 v177, 128512, v176
    v_mov_b32 v180, 0
    v_mov_b32 v181, 0
    ds_write_b64 v177, v[180:181]
k2_nz0:
    s_cmp_eq_u32 s23, 0
    s_cbranch_scc0 k2_nz1
    v_add_u32 v177, 132608, v176
    v_mov_b32 v180, 0
    v_mov_b32 v181, 0
    ds_write_b64 v177, v[180:181]
k2_nz1:
    s_cmp_eq_u32 s24, 0
    s_cbranch_scc0 k2_nz2
    v_add_u32 v177, 136704, v176
    v_mov_b32 v180, 0
    v_mov_b32 v181, 0
    ds_write_b64 v177, v[180:181]
k2_nz2:
    s_cmp_eq_u32 s25, 0
    s_cbranch_scc0 k2_nz3
    v_add_u32 v177, 140800, v176
    v_mov_b32 v180, 0
    v_mov_b32 v181, 0
    ds_write_b64 v177, v[180:181]
k2_nz3:
    s_cmp_eq_u32 s26, 0
    s_cbranch_scc0 k2_nz4
    v_add_u32 v177, 144896, v176
    v_mov_b32 v180, 0
    v_mov_b32 v181, 0
    ds_write_b64 v177, v[180:181]
k2_nz4:
    s_cmp_ge_u32 s3, 2
    s_cbranch_scc1 k2_mgdone
    v_cmp_gt_u32 vcc, 120, v0
    s_nop 0
    s_and_saveexec_b64 s[90:91], vcc
    v_mul_u32_u24 v177, 2731, v0
    v_lshrrev_b32 v177, 16, v177
    v_mul_u32_u24 v178, 24, v177
    v_sub_u32 v178, v0, v178
    v_lshlrev_b32 v178, 2, v178
    v_mul_u32_u24 v179, 192, v177
    v_add_u32 v179, v179, v178
    v_add_u32 v179, 161280, v179
    ds_read_b32 v180, v179
    ds_read_b32 v181, v179 offset:96
    v_lshlrev_b32 v182, 2, v0
    v_add_u32 v182, 162816, v182
    ds_read_b32 v183, v182
    v_lshlrev_b32 v184, 2, v177
    v_add_u32 v184, 163440, v184
    ds_read_b32 v184, v184
    v_add_u32 v179, 162240, v178
    ds_read_b32 v185, v179 offset:0
    ds_read_b32 v186, v179 offset:96
    ds_read_b32 v187, v179 offset:192
    ds_read_b32 v188, v179 offset:288
    ds_read_b32 v189, v179 offset:384
    ds_read_b32 v190, v179 offset:480
    s_waitcnt lgkmcnt(0)
    v_add_f32 v180, v180, v181
    v_cmp_ne_u32 vcc, 0, v184
    s_nop 1
    v_cndmask_b32 v180, 0, v180, vcc
    v_add_f32 v183, v183, v180
    v_add_f32 v185, v185, v186
    v_cmp_eq_u32 vcc, s7, v177
    s_nop 1
    v_cndmask_b32 v185, 0, v185, vcc
    v_add_f32 v183, v183, v185
    v_add_f32 v187, v187, v188
    v_cmp_eq_u32 vcc, s8, v177
    s_nop 1
    v_cndmask_b32 v187, 0, v187, vcc
    v_add_f32 v183, v183, v187
    v_add_f32 v189, v189, v190
    v_cmp_eq_u32 vcc, s9, v177
    s_nop 1
    v_cndmask_b32 v189, 0, v189, vcc
    v_add_f32 v183, v183, v189
    ds_write_b32 v182, v183
    s_mov_b64 exec, s[90:91]
k2_mgdone:
    s_or_b32 s10, s66, s85
    s_cmp_eq_u32 s10, 0
    s_cbranch_scc1 k2_tail
    s_waitcnt lgkmcnt(0)
    s_barrier
    v_lshlrev_b32 v176, 2, v0
    v_add_u32 v177, 128512, v176
    v_lshlrev_b32 v178, 3, v0
    s_mul_i32 s10, s2, 40960
    s_add_u32 s10, s10, 18874368
    s_mov_b32 s11, 0
k2_sp_loop:
    ds_read_b32 v180, v177
    v_mov_b32 v182, 0
    v_mov_b32 v183, 0
    s_cmp_eq_u32 s27, 0
    s_cbranch_scc1 k2_sp_first
    buffer_load_dwordx2 v[182:183], v178, s[40:43], s10 offen sc0 sc1
k2_sp_first:
    s_waitcnt vmcnt(0) lgkmcnt(0)
    v_lshlrev_b32 v184, 16, v180
    v_and_b32 v185, 0xffff0000, v180
    v_add_f32 v182, v182, v184
    v_add_f32 v183, v183, v185
    buffer_store_dwordx2 v[182:183], v178, s[40:43], s10 offen sc0 sc1
    v_add_u32 v177, 2048, v177
    s_add_u32 s10, s10, 4096
    s_add_u32 s11, s11, 1
    s_cmp_lt_u32 s11, 10
    s_cbranch_scc1 k2_sp_loop
    s_mov_b32 s27, 1
    s_cmp_eq_u32 s66, 1
    s_cbranch_scc0 k2_nb1
    s_add_u32 s67, s67, 12
    s_cmp_lt_u32 s67, 250
    s_cbranch_scc1 k2_batch_w
    s_mov_b32 s66, 3
k2_nb1:
    s_cmp_eq_u32 s85, 0
    s_cbranch_scc1 k2_tail_rare
    s_cmp_eq_u32 s66, 2
    s_cbranch_scc1 k2_ovf_more
    s_mov_b32 s66, 2
    s_mov_b32 s67, -1
    s_branch k2_ovf_next
k2_ovf_more:
    s_add_u32 s21, s31, 160
    s_mov_b32 s31, s21
    s_cmp_lt_u32 s21, s97
    s_cbranch_scc1 k2_batch_w
k2_ovf_next:
    s_add_u32 s67, s67, 1
    s_cmp_ge_u32 s67, 250
    s_cbranch_scc1 k2_tail_rare
    s_lshl_b32 s88, s67, 2
    s_add_u32 s88, s88, 15990784
    s_load_dword s97, s[36:37], s88
    s_waitcnt lgkmcnt(0)
    s_cmp_eq_u32 s97, 0
    s_cbranch_scc1 k2_ovf_next
    s_mov_b32 s21, 0
    s_mov_b32 s31, 0
k2_batch_w:
    s_waitcnt vmcnt(0) lgkmcnt(0)
    s_barrier
    s_branch k2_batch
k2_tail_rare:
    s_waitcnt vmcnt(0) lgkmcnt(0)
    v_lshlrev_b32 v176, 2, v0
    v_add_u32 v177, 128512, v176
    v_lshlrev_b32 v178, 3, v0
    s_mul_i32 s10, s2, 40960
    s_add_u32 s10, s10, 18874368
    s_mov_b32 s11, 0
k2_cv_loop:
    buffer_load_dwordx2 v[182:183], v178, s[40:43], s10 offen sc0 sc1
    s_waitcnt vmcnt(0)
    v_cvt_pk_bf16_f32 v180, v182, v183
    ds_write_b32 v177, v180
    v_add_u32 v177, 2048, v177
    s_add_u32 s10, s10, 4096
    s_add_u32 s11, s11, 1
    s_cmp_lt_u32 s11, 10
    s_cbranch_scc1 k2_cv_loop
k2_tail:
    v_and_b32 v13, 15, v1
    v_lshrrev_b32 v14, 4, v1
    s_mul_i32 s88, s2, 40
    v_lshlrev_b32 v15, 2, v14
    v_add_u32 v15, s88, v15
    v_lshlrev_b32 v15, 9, v15
    v_lshl_add_u32 v15, v13, 2, v15
    s_lshl_b32 s88, s3, 6
    v_add_u32 v15, s88, v15
    s_mov_b32 s89, 0
    buffer_load_dword v200, v15, s[56:59], s89 offen
    s_mov_b32 s89, 512
    buffer_load_dword v201, v15, s[56:59], s89 offen
    s_mov_b32 s89, 1024
    buffer_load_dword v202, v15, s[56:59], s89 offen
    s_mov_b32 s89, 1536
    buffer_load_dword v203, v15, s[56:59], s89 offen
    s_mov_b32 s89, 8192
    buffer_load_dword v204, v15, s[56:59], s89 offen
    s_mov_b32 s89, 8704
    buffer_load_dword v205, v15, s[56:59], s89 offen
    s_mov_b32 s89, 9216
    buffer_load_dword v206, v15, s[56:59], s89 offen
    s_mov_b32 s89, 9728
    buffer_load_dword v207, v15, s[56:59], s89 offen
    s_mov_b32 s89, 16384
    buffer_load_dword v208, v15, s[56:59], s89 offen
    s_mov_b32 s89, 16896
    buffer_load_dword v209, v15, s[56:59], s89 offen
    s_mov_b32 s89, 17408
    buffer_load_dword v210, v15, s[56:59], s89 offen
    s_mov_b32 s89, 17920
    buffer_load_dword v211, v15, s[56:59], s89 offen
    v_xor_b32 v11, v14, v13
    v_lshlrev_b32 v11, 4, v11
    v_add_u32 v8, 0, v13
    v_mul_u32_u24 v9, 43, v8
    v_lshrrev_b32 v9, 8, v9
    v_mul_u32_u24 v10, 6, v9
    v_sub_u32 v10, v8, v10
    v_add_u32 v12, 1, v9
    v_lshrrev_b32 v12, 1, v12
    v_lshlrev_b32 v12, 8, v12
    v_lshl_add_u32 v9, v9, 13, v12
    v_lshl_add_u32 v9, v10, 9, v9
    v_add_u32 v2, v9, v11
    v_add_u32 v8, 16, v13
    v_mul_u32_u24 v9, 43, v8
    v_lshrrev_b32 v9, 8, v9
    v_mul_u32_u24 v10, 6, v9
    v_sub_u32 v10, v8, v10
    v_add_u32 v12, 1, v9
    v_lshrrev_b32 v12, 1, v12
    v_lshlrev_b32 v12, 8, v12
    v_lshl_add_u32 v9, v9, 13, v12
    v_lshl_add_u32 v9, v10, 9, v9
    v_add_u32 v3, v9, v11
    v_add_u32 v8, 32, v13
    v_mul_u32_u24 v9, 43, v8
    v_lshrrev_b32 v9, 8, v9
    v_mul_u32_u24 v10, 6, v9
    v_sub_u32 v10, v8, v10
    v_add_u32 v12, 1, v9
    v_lshrrev_b32 v12, 1, v12
    v_lshlrev_b32 v12, 8, v12
    v_lshl_add_u32 v9, v9, 13, v12
    v_lshl_add_u32 v9, v10, 9, v9
    v_add_u32 v4, v9, v11
    v_xor_b32 v12, 0, v2
    ds_read_b128 v[212:215], v12 offset:0
    v_xor_b32 v12, 0, v3
    ds_read_b128 v[216:219], v12 offset:0
    v_xor_b32 v12, 0, v4
    ds_read_b128 v[220:223], v12 offset:0
    v_xor_b32 v12, 64, v2
    ds_read_b128 v[224:227], v12 offset:0
    v_xor_b32 v12, 64, v3
    ds_read_b128 v[228:231], v12 offset:0
    v_xor_b32 v12, 64, v4
    ds_read_b128 v[232:235], v12 offset:0
    s_waitcnt vmcnt(42) lgkmcnt(3)
    v_mfma_f32_16x16x32_bf16 v[176:179], v[212:215], v[112:115], 0
    v_mfma_f32_16x16x32_bf16 v[184:187], v[216:219], v[112:115], 0
    v_mfma_f32_16x16x32_bf16 v[192:195], v[220:223], v[112:115], 0
    v_mfma_f32_16x16x32_bf16 v[180:183], v[212:215], v[116:119], 0
    v_mfma_f32_16x16x32_bf16 v[188:191], v[216:219], v[116:119], 0
    v_mfma_f32_16x16x32_bf16 v[196:199], v[220:223], v[116:119], 0
    v_xor_b32 v12, 128, v2
    ds_read_b128 v[212:215], v12 offset:0
    v_xor_b32 v12, 128, v3
    ds_read_b128 v[216:219], v12 offset:0
    v_xor_b32 v12, 128, v4
    ds_read_b128 v[220:223], v12 offset:0
    s_waitcnt vmcnt(40) lgkmcnt(3)
    v_mfma_f32_16x16x32_bf16 v[176:179], v[224:227], v[120:123], v[176:179]
    v_mfma_f32_16x16x32_bf16 v[184:187], v[228:231], v[120:123], v[184:187]
    v_mfma_f32_16x16x32_bf16 v[192:195], v[232:235], v[120:123], v[192:195]
    v_mfma_f32_16x16x32_bf16 v[180:183], v[224:227], v[124:127], v[180:183]
    v_mfma_f32_16x16x32_bf16 v[188:191], v[228:231], v[124:127], v[188:191]
    v_mfma_f32_16x16x32_bf16 v[196:199], v[232:235], v[124:127], v[196:199]
    v_xor_b32 v12, 192, v2
    ds_read_b128 v[224:227], v12 offset:0
    v_xor_b32 v12, 192, v3
    ds_read_b128 v[228:231], v12 offset:0
    v_xor_b32 v12, 192, v4
    ds_read_b128 v[232:235], v12 offset:0
    s_waitcnt vmcnt(38) lgkmcnt(3)
    v_mfma_f32_16x16x32_bf16 v[176:179], v[212:215], v[128:131], v[176:179]
    v_mfma_f32_16x16x32_bf16 v[184:187], v[216:219], v[128:131], v[184:187]
    v_mfma_f32_16x16x32_bf16 v[192:195], v[220:223], v[128:131], v[192:195]
    v_mfma_f32_16x16x32_bf16 v[180:183], v[212:215], v[132:135], v[180:183]
    v_mfma_f32_16x16x32_bf16 v[188:191], v[216:219], v[132:135], v[188:191]
    v_mfma_f32_16x16x32_bf16 v[196:199], v[220:223], v[132:135], v[196:199]
    v_xor_b32 v12, 0, v2
    ds_read_b128 v[212:215], v12 offset:256
    v_xor_b32 v12, 0, v3
    ds_read_b128 v[216:219], v12 offset:256
    v_xor_b32 v12, 0, v4
    ds_read_b128 v[220:223], v12 offset:256
    s_waitcnt vmcnt(36) lgkmcnt(3)
    v_mfma_f32_16x16x32_bf16 v[176:179], v[224:227], v[136:139], v[176:179]
    v_mfma_f32_16x16x32_bf16 v[184:187], v[228:231], v[136:139], v[184:187]
    v_mfma_f32_16x16x32_bf16 v[192:195], v[232:235], v[136:139], v[192:195]
    v_mfma_f32_16x16x32_bf16 v[180:183], v[224:227], v[140:143], v[180:183]
    v_mfma_f32_16x16x32_bf16 v[188:191], v[228:231], v[140:143], v[188:191]
    v_mfma_f32_16x16x32_bf16 v[196:199], v[232:235], v[140:143], v[196:199]
    v_xor_b32 v12, 64, v2
    ds_read_b128 v[224:227], v12 offset:256
    v_xor_b32 v12, 64, v3
    ds_read_b128 v[228:231], v12 offset:256
    v_xor_b32 v12, 64, v4
    ds_read_b128 v[232:235], v12 offset:256
    s_waitcnt vmcnt(34) lgkmcnt(3)
    v_mfma_f32_16x16x32_bf16 v[176:179], v[212:215], v[144:147], v[176:179]
    v_mfma_f32_16x16x32_bf16 v[184:187], v[216:219], v[144:147], v[184:187]
    v_mfma_f32_16x16x32_bf16 v[192:195], v[220:223], v[144:147], v[192:195]
    v_mfma_f32_16x16x32_bf16 v[180:183], v[212:215], v[148:151], v[180:183]
    v_mfma_f32_16x16x32_bf16 v[188:191], v[216:219], v[148:151], v[188:191]
    v_mfma_f32_16x16x32_bf16 v[196:199], v[220:223], v[148:151], v[196:199]
    v_xor_b32 v12, 128, v2
    ds_read_b128 v[212:215], v12 offset:256
    v_xor_b32 v12, 128, v3
    ds_read_b128 v[216:219], v12 offset:256
    v_xor_b32 v12, 128, v4
    ds_read_b128 v[220:223], v12 offset:256
    s_waitcnt vmcnt(32) lgkmcnt(3)
    v_mfma_f32_16x16x32_bf16 v[176:179], v[224:227], v[152:155], v[176:179]
    v_mfma_f32_16x16x32_bf16 v[184:187], v[228:231], v[152:155], v[184:187]
    v_mfma_f32_16x16x32_bf16 v[192:195], v[232:235], v[152:155], v[192:195]
    v_mfma_f32_16x16x32_bf16 v[180:183], v[224:227], v[156:159], v[180:183]
    v_mfma_f32_16x16x32_bf16 v[188:191], v[228:231], v[156:159], v[188:191]
    v_mfma_f32_16x16x32_bf16 v[196:199], v[232:235], v[156:159], v[196:199]
    v_xor_b32 v12, 192, v2
    ds_read_b128 v[224:227], v12 offset:256
    v_xor_b32 v12, 192, v3
    ds_read_b128 v[228:231], v12 offset:256
    v_xor_b32 v12, 192, v4
    ds_read_b128 v[232:235], v12 offset:256
    s_waitcnt vmcnt(30) lgkmcnt(3)
    v_mfma_f32_16x16x32_bf16 v[176:179], v[212:215], v[160:163], v[176:179]
    v_mfma_f32_16x16x32_bf16 v[184:187], v[216:219], v[160:163], v[184:187]
    v_mfma_f32_16x16x32_bf16 v[192:195], v[220:223], v[160:163], v[192:195]
    v_mfma_f32_16x16x32_bf16 v[180:183], v[212:215], v[164:167], v[180:183]
    v_mfma_f32_16x16x32_bf16 v[188:191], v[216:219], v[164:167], v[188:191]
    v_mfma_f32_16x16x32_bf16 v[196:199], v[220:223], v[164:167], v[196:199]
    s_waitcnt vmcnt(28) lgkmcnt(0)
    v_mfma_f32_16x16x32_bf16 v[176:179], v[224:227], v[168:171], v[176:179]
    v_mfma_f32_16x16x32_bf16 v[184:187], v[228:231], v[168:171], v[184:187]
    v_mfma_f32_16x16x32_bf16 v[192:195], v[232:235], v[168:171], v[192:195]
    v_mfma_f32_16x16x32_bf16 v[180:183], v[224:227], v[172:175], v[180:183]
    v_mfma_f32_16x16x32_bf16 v[188:191], v[228:231], v[172:175], v[188:191]
    v_mfma_f32_16x16x32_bf16 v[196:199], v[232:235], v[172:175], v[196:199]
    v_lshl_add_u32 v11, v13, 9, v11
    v_add_u32 v11, 128512, v11
    s_waitcnt lgkmcnt(0)
    s_barrier
    v_xor_b32 v12, 0, v11
    ds_read_b128 v[212:215], v12 offset:0
    ds_read_b128 v[216:219], v12 offset:8192
    ds_read_b128 v[220:223], v12 offset:16384
    v_xor_b32 v12, 64, v11
    ds_read_b128 v[224:227], v12 offset:0
    ds_read_b128 v[228:231], v12 offset:8192
    ds_read_b128 v[232:235], v12 offset:16384
    s_waitcnt vmcnt(26) lgkmcnt(3)
    v_mfma_f32_16x16x32_bf16 v[176:179], v[212:215], v[16:19], v[176:179]
    v_mfma_f32_16x16x32_bf16 v[184:187], v[216:219], v[16:19], v[184:187]
    v_mfma_f32_16x16x32_bf16 v[192:195], v[220:223], v[16:19], v[192:195]
    v_mfma_f32_16x16x32_bf16 v[180:183], v[212:215], v[20:23], v[180:183]
    v_mfma_f32_16x16x32_bf16 v[188:191], v[216:219], v[20:23], v[188:191]
    v_mfma_f32_16x16x32_bf16 v[196:199], v[220:223], v[20:23], v[196:199]
    v_xor_b32 v12, 128, v11
    ds_read_b128 v[212:215], v12 offset:0
    ds_read_b128 v[216:219], v12 offset:8192
    ds_read_b128 v[220:223], v12 offset:16384
    s_waitcnt vmcnt(24) lgkmcnt(3)
    v_mfma_f32_16x16x32_bf16 v[176:179], v[224:227], v[24:27], v[176:179]
    v_mfma_f32_16x16x32_bf16 v[184:187], v[228:231], v[24:27], v[184:187]
    v_mfma_f32_16x16x32_bf16 v[192:195], v[232:235], v[24:27], v[192:195]
    v_mfma_f32_16x16x32_bf16 v[180:183], v[224:227], v[28:31], v[180:183]
    v_mfma_f32_16x16x32_bf16 v[188:191], v[228:231], v[28:31], v[188:191]
    v_mfma_f32_16x16x32_bf16 v[196:199], v[232:235], v[28:31], v[196:199]
    v_xor_b32 v12, 192, v11
    ds_read_b128 v[224:227], v12 offset:0
    ds_read_b128 v[228:231], v12 offset:8192
    ds_read_b128 v[232:235], v12 offset:16384
    s_waitcnt vmcnt(22) lgkmcnt(3)
    v_mfma_f32_16x16x32_bf16 v[176:179], v[212:215], v[32:35], v[176:179]
    v_mfma_f32_16x16x32_bf16 v[184:187], v[216:219], v[32:35], v[184:187]
    v_mfma_f32_16x16x32_bf16 v[192:195], v[220:223], v[32:35], v[192:195]
    v_mfma_f32_16x16x32_bf16 v[180:183], v[212:215], v[36:39], v[180:183]
    v_mfma_f32_16x16x32_bf16 v[188:191], v[216:219], v[36:39], v[188:191]
    v_mfma_f32_16x16x32_bf16 v[196:199], v[220:223], v[36:39], v[196:199]
    v_xor_b32 v12, 0, v11
    ds_read_b128 v[212:215], v12 offset:256
    ds_read_b128 v[216:219], v12 offset:8448
    ds_read_b128 v[220:223], v12 offset:16640
    s_waitcnt vmcnt(20) lgkmcnt(3)
    v_mfma_f32_16x16x32_bf16 v[176:179], v[224:227], v[40:43], v[176:179]
    v_mfma_f32_16x16x32_bf16 v[184:187], v[228:231], v[40:43], v[184:187]
    v_mfma_f32_16x16x32_bf16 v[192:195], v[232:235], v[40:43], v[192:195]
    v_mfma_f32_16x16x32_bf16 v[180:183], v[224:227], v[44:47], v[180:183]
    v_mfma_f32_16x16x32_bf16 v[188:191], v[228:231], v[44:47], v[188:191]
    v_mfma_f32_16x16x32_bf16 v[196:199], v[232:235], v[44:47], v[196:199]
    v_xor_b32 v12, 64, v11
    ds_read_b128 v[224:227], v12 offset:256
    ds_read_b128 v[228:231], v12 offset:8448
    ds_read_b128 v[232:235], v12 offset:16640
    s_waitcnt vmcnt(18) lgkmcnt(3)
    v_mfma_f32_16x16x32_bf16 v[176:179], v[212:215], v[48:51], v[176:179]
    v_mfma_f32_16x16x32_bf16 v[184:187], v[216:219], v[48:51], v[184:187]
    v_mfma_f32_16x16x32_bf16 v[192:195], v[220:223], v[48:51], v[192:195]
    v_mfma_f32_16x16x32_bf16 v[180:183], v[212:215], v[52:55], v[180:183]
    v_mfma_f32_16x16x32_bf16 v[188:191], v[216:219], v[52:55], v[188:191]
    v_mfma_f32_16x16x32_bf16 v[196:199], v[220:223], v[52:55], v[196:199]
    v_xor_b32 v12, 128, v11
    ds_read_b128 v[212:215], v12 offset:256
    ds_read_b128 v[216:219], v12 offset:8448
    ds_read_b128 v[220:223], v12 offset:16640
    s_waitcnt vmcnt(16) lgkmcnt(3)
    v_mfma_f32_16x16x32_bf16 v[176:179], v[224:227], v[56:59], v[176:179]
    v_mfma_f32_16x16x32_bf16 v[184:187], v[228:231], v[56:59], v[184:187]
    v_mfma_f32_16x16x32_bf16 v[192:195], v[232:235], v[56:59], v[192:195]
    v_mfma_f32_16x16x32_bf16 v[180:183], v[224:227], v[60:63], v[180:183]
    v_mfma_f32_16x16x32_bf16 v[188:191], v[228:231], v[60:63], v[188:191]
    v_mfma_f32_16x16x32_bf16 v[196:199], v[232:235], v[60:63], v[196:199]
    v_xor_b32 v12, 192, v11
    ds_read_b128 v[224:227], v12 offset:256
    ds_read_b128 v[228:231], v12 offset:8448
    ds_read_b128 v[232:235], v12 offset:16640
    s_waitcnt vmcnt(14) lgkmcnt(3)
    v_mfma_f32_16x16x32_bf16 v[176:179], v[212:215], v[64:67], v[176:179]
    v_mfma_f32_16x16x32_bf16 v[184:187], v[216:219], v[64:67], v[184:187]
    v_mfma_f32_16x16x32_bf16 v[192:195], v[220:223], v[64:67], v[192:195]
    v_mfma_f32_16x16x32_bf16 v[180:183], v[212:215], v[68:71], v[180:183]
    v_mfma_f32_16x16x32_bf16 v[188:191], v[216:219], v[68:71], v[188:191]
    v_mfma_f32_16x16x32_bf16 v[196:199], v[220:223], v[68:71], v[196:199]
    s_waitcnt vmcnt(12) lgkmcnt(0)
    v_mfma_f32_16x16x32_bf16 v[176:179], v[224:227], v[72:75], v[176:179]
    v_mfma_f32_16x16x32_bf16 v[184:187], v[228:231], v[72:75], v[184:187]
    v_mfma_f32_16x16x32_bf16 v[192:195], v[232:235], v[72:75], v[192:195]
    v_mfma_f32_16x16x32_bf16 v[180:183], v[224:227], v[76:79], v[180:183]
    v_mfma_f32_16x16x32_bf16 v[188:191], v[228:231], v[76:79], v[188:191]
    v_mfma_f32_16x16x32_bf16 v[196:199], v[232:235], v[76:79], v[196:199]
    s_nop 2
    v_mul_f32 v16, s92, v176
    v_mul_f32 v17, s92, v177
    v_mul_f32 v18, s92, v178
    v_mul_f32 v19, s92, v179
    v_mul_f32 v20, s92, v180
    v_mul_f32 v21, s92, v181
    v_mul_f32 v22, s92, v182
    v_mul_f32 v23, s92, v183
    v_mul_f32 v24, s92, v184
    v_mul_f32 v25, s92, v185
    v_mul_f32 v26, s92, v186
    v_mul_f32 v27, s92, v187
    v_mul_f32 v28, s92, v188
    v_mul_f32 v29, s92, v189
    v_mul_f32 v30, s92, v190
    v_mul_f32 v31, s92, v191
    v_mul_f32 v32, s92, v192
    v_mul_f32 v33, s92, v193
    v_mul_f32 v34, s92, v194
    v_mul_f32 v35, s92, v195
    v_mul_f32 v36, s92, v196
    v_mul_f32 v37, s92, v197
    v_mul_f32 v38, s92, v198
    v_mul_f32 v39, s92, v199
    v_exp_f32 v16, v16
    v_exp_f32 v17, v17
    v_exp_f32 v18, v18
    v_exp_f32 v19, v19
    v_exp_f32 v20, v20
    v_exp_f32 v21, v21
    v_exp_f32 v22, v22
    v_exp_f32 v23, v23
    v_exp_f32 v24, v24
    v_exp_f32 v25, v25
    v_exp_f32 v26, v26
    v_exp_f32 v27, v27
    v_exp_f32 v28, v28
    v_exp_f32 v29, v29
    v_exp_f32 v30, v30
    v_exp_f32 v31, v31
    v_exp_f32 v32, v32
    v_exp_f32 v33, v33
    v_exp_f32 v34, v34
    v_exp_f32 v35, v35
    v_exp_f32 v36, v36
    v_exp_f32 v37, v37
    v_exp_f32 v38, v38
    v_exp_f32 v39, v39
    v_add_f32 v16, 1.0, v16
    v_add_f32 v17, 1.0, v17
    v_add_f32 v18, 1.0, v18
    v_add_f32 v19, 1.0, v19
    v_add_f32 v20, 1.0, v20
    v_add_f32 v21, 1.0, v21
    v_add_f32 v22, 1.0, v22
    v_add_f32 v23, 1.0, v23
    v_add_f32 v24, 1.0, v24
    v_add_f32 v25, 1.0, v25
    v_add_f32 v26, 1.0, v26
    v_add_f32 v27, 1.0, v27
    v_add_f32 v28, 1.0, v28
    v_add_f32 v29, 1.0, v29
    v_add_f32 v30, 1.0, v30
    v_add_f32 v31, 1.0, v31
    v_add_f32 v32, 1.0, v32
    v_add_f32 v33, 1.0, v33
    v_add_f32 v34, 1.0, v34
    v_add_f32 v35, 1.0, v35
    v_add_f32 v36, 1.0, v36
    v_add_f32 v37, 1.0, v37
    v_add_f32 v38, 1.0, v38
    v_add_f32 v39, 1.0, v39
    v_rcp_f32 v16, v16
    v_rcp_f32 v17, v17
    v_rcp_f32 v18, v18
    v_rcp_f32 v19, v19
    v_rcp_f32 v20, v20
    v_rcp_f32 v21, v21
    v_rcp_f32 v22, v22
    v_rcp_f32 v23, v23
    v_rcp_f32 v24, v24
    v_rcp_f32 v25, v25
    v_rcp_f32 v26, v26
    v_rcp_f32 v27, v27
    v_rcp_f32 v28, v28
    v_rcp_f32 v29, v29
    v_rcp_f32 v30, v30
    v_rcp_f32 v31, v31
    v_rcp_f32 v32, v32
    v_rcp_f32 v33, v33
    v_rcp_f32 v34, v34
    v_rcp_f32 v35, v35
    v_rcp_f32 v36, v36
    v_rcp_f32 v37, v37
    v_rcp_f32 v38, v38
    v_rcp_f32 v39, v39
    v_pk_mul_f32 v[176:177], v[176:177], v[16:17]
    v_pk_mul_f32 v[178:179], v[178:179], v[18:19]
    v_pk_mul_f32 v[180:181], v[180:181], v[20:21]
    v_pk_mul_f32 v[182:183], v[182:183], v[22:23]
    v_pk_mul_f32 v[184:185], v[184:185], v[24:25]
    v_pk_mul_f32 v[186:187], v[186:187], v[26:27]
    v_pk_mul_f32 v[188:189], v[188:189], v[28:29]
    v_pk_mul_f32 v[190:191], v[190:191], v[30:31]
    v_pk_mul_f32 v[192:193], v[192:193], v[32:33]
    v_pk_mul_f32 v[194:195], v[194:195], v[34:35]
    v_pk_mul_f32 v[196:197], v[196:197], v[36:37]
    v_pk_mul_f32 v[198:199], v[198:199], v[38:39]
    s_waitcnt vmcnt(0)
    v_lshlrev_b32 v16, 16, v200
    v_and_b32 v20, 0xffff0000, v200
    v_lshlrev_b32 v17, 16, v201
    v_and_b32 v21, 0xffff0000, v201
    v_lshlrev_b32 v18, 16, v202
    v_and_b32 v22, 0xffff0000, v202
    v_lshlrev_b32 v19, 16, v203
    v_and_b32 v23, 0xffff0000, v203
    v_lshlrev_b32 v24, 16, v204
    v_and_b32 v28, 0xffff0000, v204
    v_lshlrev_b32 v25, 16, v205
    v_and_b32 v29, 0xffff0000, v205
    v_lshlrev_b32 v26, 16, v206
    v_and_b32 v30, 0xffff0000, v206
    v_lshlrev_b32 v27, 16, v207
    v_and_b32 v31, 0xffff0000, v207
    v_lshlrev_b32 v32, 16, v208
    v_and_b32 v36, 0xffff0000, v208
    v_lshlrev_b32 v33, 16, v209
    v_and_b32 v37, 0xffff0000, v209
    v_lshlrev_b32 v34, 16, v210
    v_and_b32 v38, 0xffff0000, v210
    v_lshlrev_b32 v35, 16, v211
    v_and_b32 v39, 0xffff0000, v211
    v_pk_add_f32 v[176:177], v[176:177], v[16:17]
    v_pk_add_f32 v[178:179], v[178:179], v[18:19]
    v_pk_add_f32 v[180:181], v[180:181], v[20:21]
    v_pk_add_f32 v[182:183], v[182:183], v[22:23]
    v_pk_add_f32 v[184:185], v[184:185], v[24:25]
    v_pk_add_f32 v[186:187], v[186:187], v[26:27]
    v_pk_add_f32 v[188:189], v[188:189], v[28:29]
    v_pk_add_f32 v[190:191], v[190:191], v[30:31]
    v_pk_add_f32 v[192:193], v[192:193], v[32:33]
    v_pk_add_f32 v[194:195], v[194:195], v[34:35]
    v_pk_add_f32 v[196:197], v[196:197], v[36:37]
    v_pk_add_f32 v[198:199], v[198:199], v[38:39]
    v_cvt_pk_bf16_f32 v200, v176, v180
    v_cvt_pk_bf16_f32 v201, v177, v181
    v_cvt_pk_bf16_f32 v202, v178, v182
    v_cvt_pk_bf16_f32 v203, v179, v183
    v_cvt_pk_bf16_f32 v204, v184, v188
    v_cvt_pk_bf16_f32 v205, v185, v189
    v_cvt_pk_bf16_f32 v206, v186, v190
    v_cvt_pk_bf16_f32 v207, v187, v191
    v_cvt_pk_bf16_f32 v208, v192, v196
    v_cvt_pk_bf16_f32 v209, v193, v197
    v_cvt_pk_bf16_f32 v210, v194, v198
    v_cvt_pk_bf16_f32 v211, v195, v199
    s_mov_b32 s89, 0
    buffer_store_dword v200, v15, s[60:63], s89 offen
    s_mov_b32 s89, 512
    buffer_store_dword v201, v15, s[60:63], s89 offen
    s_mov_b32 s89, 1024
    buffer_store_dword v202, v15, s[60:63], s89 offen
    s_mov_b32 s89, 1536
    buffer_store_dword v203, v15, s[60:63], s89 offen
    s_mov_b32 s89, 8192
    buffer_store_dword v204, v15, s[60:63], s89 offen
    s_mov_b32 s89, 8704
    buffer_store_dword v205, v15, s[60:63], s89 offen
    s_mov_b32 s89, 9216
    buffer_store_dword v206, v15, s[60:63], s89 offen
    s_mov_b32 s89, 9728
    buffer_store_dword v207, v15, s[60:63], s89 offen
    s_mov_b32 exec_hi, 0
    s_mov_b32 s89, 16384
    buffer_store_dword v208, v15, s[60:63], s89 offen
    s_mov_b32 s89, 16896
    buffer_store_dword v209, v15, s[60:63], s89 offen
    s_mov_b32 s89, 17408
    buffer_store_dword v210, v15, s[60:63], s89 offen
    s_mov_b32 s89, 17920
    buffer_store_dword v211, v15, s[60:63], s89 offen
    s_mov_b64 exec, -1
    s_cmp_ge_u32 s3, 2
    s_cbranch_scc1 k2_done
    v_cmp_gt_u32 vcc, 120, v0
    s_nop 0
    s_and_saveexec_b64 s[90:91], vcc
    s_cbranch_execz k2_done
    v_mul_u32_u24 v16, 21846, v0
    v_lshrrev_b32 v16, 16, v16
    v_mul_u32_u24 v17, 3, v16
    v_sub_u32 v17, v0, v17
    v_lshrrev_b32 v18, 3, v16
    v_mul_u32_u24 v18, 24, v18
    v_and_b32 v19, 1, v16
    v_mul_u32_u24 v19, 12, v19
    v_add_u32 v18, v18, v19
    v_bfe_u32 v19, v16, 1, 2
    v_mul_u32_u24 v19, 3, v19
    v_add3_u32 v18, v18, v19, v17
    v_lshlrev_b32 v18, 2, v18
    v_add_u32 v18, 162816, v18
    ds_read_b32 v16, v18
    s_mul_i32 s88, s2, 240
    v_lshlrev_b32 v13, 1, v0
    buffer_load_ushort v20, v13, s[52:55], s88 offen
    s_waitcnt vmcnt(0) lgkmcnt(0)
    v_lshlrev_b32 v20, 16, v20
    v_add_f32 v16, v16, v20
    v_cvt_pk_bf16_f32 v16, v16, v7
    s_add_u32 s88, s88, 5120000
    buffer_store_short v16, v13, s[60:63], s88 offen
k2_done:
    s_endpgm
k2_wdaf:
    s_bfe_u32 s88, s94, 0x30010
    s_lshl_b32 s88, s88, 12
    v_add_u32 v10, s88, v9
    s_mov_b32 exec_hi, 0
    ds_read_b128 v[160:163], v10 offset:0
    ds_read_b128 v[164:167], v10 offset:512
    ds_read_b128 v[168:171], v10 offset:1024
    ds_read_b128 v[172:175], v10 offset:1536
    s_mov_b32 exec_hi, -1
    s_branch k2_wdarf
k2_latef:
    s_cmp_eq_u32 s12, 0
    s_cbranch_scc0 k2_late2f
    s_mov_b32 s12, 1
    v_lshrrev_b32 v13, 5, v1
    s_mul_i32 s89, s3, 6
    v_add_u32 v13, s89, v13
    v_and_b32 v10, 31, v1
    s_mul_i32 s90, s2, 40
    v_and_b32 v11, 15, v13
    v_xor_b32 v11, v11, v10
    v_lshlrev_b32 v11, 4, v11
    v_add_u32 v12, s90, v13
    v_lshl_add_u32 v11, v12, 9, v11
    s_and_b32 s91, s3, 1
    s_lshl_b32 s91, s91, 7
    s_add_u32 s91, s91, s87
    s_add_u32 m0, s91, 0
    s_nop 0
    buffer_load_dwordx4 v11, s[56:59], 0 offen lds
    v_add_u32 v13, 2, v13
    v_and_b32 v11, 15, v13
    v_xor_b32 v11, v11, v10
    v_lshlrev_b32 v11, 4, v11
    v_add_u32 v12, s90, v13
    v_lshl_add_u32 v11, v12, 9, v11
    s_and_b32 s91, s3, 1
    s_lshl_b32 s91, s91, 7
    s_add_u32 s91, s91, s87
    s_add_u32 m0, s91, 1024
    s_nop 0
    buffer_load_dwordx4 v11, s[56:59], 0 offen lds
    v_add_u32 v13, 2, v13
    v_and_b32 v11, 15, v13
    v_xor_b32 v11, v11, v10
    v_lshlrev_b32 v11, 4, v11
    v_add_u32 v12, s90, v13
    v_lshl_add_u32 v11, v12, 9, v11
    s_and_b32 s91, s3, 1
    s_lshl_b32 s91, s91, 7
    s_add_u32 s91, s91, s87
    s_add_u32 m0, s91, 2048
    s_nop 0
    buffer_load_dwordx4 v11, s[56:59], 0 offen lds
k2_late2f:
    s_bitcmp1_b32 s94, 20
    s_cbranch_scc1 k2_nx3f
    v_lshlrev_b32 v12, 4, v1
    s_lshl_b32 s88, s3, 15
    s_add_u32 s88, s88, 16121856
    s_add_u32 s89, s88, 0
    buffer_load_dwordx4 v[112:115], v12, s[40:43], s89 offen
    s_add_u32 s89, s88, 1024
    buffer_load_dwordx4 v[116:119], v12, s[40:43], s89 offen
    s_add_u32 s89, s88, 2048
    buffer_load_dwordx4 v[120:123], v12, s[40:43], s89 offen
    s_add_u32 s89, s88, 3072
    buffer_load_dwordx4 v[124:127], v12, s[40:43], s89 offen
    s_add_u32 s89, s88, 4096
    buffer_load_dwordx4 v[128:131], v12, s[40:43], s89 offen
    s_add_u32 s89, s88, 5120
    buffer_load_dwordx4 v[132:135], v12, s[40:43], s89 offen
    s_add_u32 s89, s88, 6144
    buffer_load_dwordx4 v[136:139], v12, s[40:43], s89 offen
    s_add_u32 s89, s88, 7168
    buffer_load_dwordx4 v[140:143], v12, s[40:43], s89 offen
    s_add_u32 s89, s88, 8192
    buffer_load_dwordx4 v[144:147], v12, s[40:43], s89 offen
    s_add_u32 s89, s88, 9216
    buffer_load_dwordx4 v[148:151], v12, s[40:43], s89 offen
    s_add_u32 s89, s88, 10240
    buffer_load_dwordx4 v[152:155], v12, s[40:43], s89 offen
    s_add_u32 s89, s88, 11264
    buffer_load_dwordx4 v[156:159], v12, s[40:43], s89 offen
    s_add_u32 s89, s88, 12288
    buffer_load_dwordx4 v[160:163], v12, s[40:43], s89 offen
    s_add_u32 s89, s88, 13312
    buffer_load_dwordx4 v[164:167], v12, s[40:43], s89 offen
    s_add_u32 s89, s88, 14336
    buffer_load_dwordx4 v[168:171], v12, s[40:43], s89 offen
    s_add_u32 s89, s88, 15360
    buffer_load_dwordx4 v[172:175], v12, s[40:43], s89 offen
    s_branch k2_nx3f
k2_gen:
    s_bfe_u32 s81, s78, 0x6000a
    s_nop 5
    v_exp_f32 v200, v80
    v_mfma_f32_32x32x16_bf16 v[64:79], v[184:187], v[96:99], v[64:79]
    v_exp_f32 v201, v81
    v_exp_f32 v202, v82
    v_exp_f32 v203, v83
    v_add_f32 v200, 1.0, v200
    v_add_f32 v201, 1.0, v201
    v_add_f32 v202, 1.0, v202
    v_add_f32 v203, 1.0, v203
    v_rcp_f32 v200, v200
    v_mfma_f32_32x32x16_bf16 v[64:79], v[188:191], v[100:103], v[64:79]
    v_rcp_f32 v201, v201
    v_rcp_f32 v202, v202
    v_rcp_f32 v203, v203
    v_pk_mul_f32 v[80:81], v[80:81], v[200:201]
    v_pk_mul_f32 v[82:83], v[82:83], v[202:203]
    v_cvt_pk_bf16_f32 v80, v80, v81
    v_cvt_pk_bf16_f32 v81, v82, v83
    s_bfm_b32 s88, s81, 0
    s_mov_b32 exec_lo, s88
    s_mov_b32 exec_hi, s88
    ds_write_b16 v14, v216
    ds_write_b16_d16_hi v14, v216 offset:16
    s_mov_b64 exec, -1
    ds_read_b128 v[184:187], v4
    ds_read_b128 v[188:191], v4 offset:1024
    s_mov_b32 exec_lo, s88
    s_mov_b32 exec_hi, s88
    ds_write_b16 v14, v7
    ds_write_b16 v14, v7 offset:16
    s_mov_b64 exec, -1
    s_cmp_le_u32 s81, 8
    s_cbranch_scc1 k2_qs18
    v_exp_f32 v204, v84
    v_mfma_f32_32x32x16_bf16 v[96:111], v[120:123], v[176:179], 0
    v_exp_f32 v205, v85
    v_exp_f32 v206, v86
    v_exp_f32 v207, v87
    v_add_f32 v204, 1.0, v204
    v_add_f32 v205, 1.0, v205
    v_add_f32 v206, 1.0, v206
    v_add_f32 v207, 1.0, v207
    v_rcp_f32 v204, v204
    v_mfma_f32_32x32x16_bf16 v[96:111], v[124:127], v[180:183], v[96:111]
    v_rcp_f32 v205, v205
    v_rcp_f32 v206, v206
    v_rcp_f32 v207, v207
    v_pk_mul_f32 v[84:85], v[84:85], v[204:205]
    v_pk_mul_f32 v[86:87], v[86:87], v[206:207]
    v_cvt_pk_bf16_f32 v82, v84, v85
    v_cvt_pk_bf16_f32 v83, v86, v87
k2_qe18:
    s_cmp_le_u32 s81, 16
    s_cbranch_scc1 k2_qs19
    v_exp_f32 v200, v88
    v_mfma_f32_32x32x16_bf16 v[96:111], v[196:199], v[148:151], v[96:111]
    v_exp_f32 v201, v89
    v_exp_f32 v202, v90
    v_exp_f32 v203, v91
    v_add_f32 v200, 1.0, v200
    v_add_f32 v201, 1.0, v201
    v_add_f32 v202, 1.0, v202
    v_add_f32 v203, 1.0, v203
    v_rcp_f32 v200, v200
    v_rcp_f32 v201, v201
    v_rcp_f32 v202, v202
    v_rcp_f32 v203, v203
    v_pk_mul_f32 v[88:89], v[88:89], v[200:201]
    v_pk_mul_f32 v[90:91], v[90:91], v[202:203]
    v_cvt_pk_bf16_f32 v84, v88, v89
    v_cvt_pk_bf16_f32 v85, v90, v91
k2_qe19:
    s_cmp_le_u32 s81, 24
    s_cbranch_scc1 k2_qs20
    v_exp_f32 v204, v92
    v_mfma_f32_32x32x16_bf16 v[96:111], v[192:195], v[164:167], v[96:111]
    v_exp_f32 v205, v93
    v_exp_f32 v206, v94
    v_exp_f32 v207, v95
    v_add_f32 v204, 1.0, v204
    v_add_f32 v205, 1.0, v205
    v_add_f32 v206, 1.0, v206
    v_add_f32 v207, 1.0, v207
    v_rcp_f32 v204, v204
    v_rcp_f32 v205, v205
    v_rcp_f32 v206, v206
    v_rcp_f32 v207, v207
    v_pk_mul_f32 v[92:93], v[92:93], v[204:205]
    v_pk_mul_f32 v[94:95], v[94:95], v[206:207]
    v_cvt_pk_bf16_f32 v86, v92, v93
    v_cvt_pk_bf16_f32 v87, v94, v95
k2_qe20:
    s_bitcmp1_b32 s13, 19
    s_cbranch_scc1 k2_flush
k2_noflg:
    s_waitcnt lgkmcnt(0)
    s_nop 7
    v_exp_f32 v200, v96
    v_mfma_f32_32x32x16_bf16 v[16:31], v[184:187], v[80:83], v[16:31]
    v_exp_f32 v201, v97
    v_exp_f32 v202, v98
    v_exp_f32 v203, v99
    v_add_f32 v200, 1.0, v200
    v_add_f32 v201, 1.0, v201
    v_add_f32 v202, 1.0, v202
    v_add_f32 v203, 1.0, v203
    v_rcp_f32 v200, v200
    v_mfma_f32_32x32x16_bf16 v[16:31], v[188:191], v[84:87], v[16:31]
    v_rcp_f32 v201, v201
    v_rcp_f32 v202, v202
    v_rcp_f32 v203, v203
    v_pk_mul_f32 v[96:97], v[96:97], v[200:201]
    v_pk_mul_f32 v[98:99], v[98:99], v[202:203]
    v_cvt_pk_bf16_f32 v96, v96, v97
    v_cvt_pk_bf16_f32 v97, v98, v99
    s_and_b32 s89, s94, 0x3ff
    s_lshl_b32 s88, s89, 2
    v_add_u32 v11, s88, v243
    ds_read_b32 v218, v11
    ds_read_b32 v219, v11 offset:3968
    v_add_u32 v13, s89, v244
    ds_read_u8 v220, v13
    s_cmp_le_u32 s81, 8
    s_cbranch_scc1 k2_qs22
    v_exp_f32 v204, v100
    v_mfma_f32_32x32x16_bf16 v[80:95], v[128:131], v[176:179], 0
    v_exp_f32 v205, v101
    v_exp_f32 v206, v102
    v_exp_f32 v207, v103
    v_add_f32 v204, 1.0, v204
    v_add_f32 v205, 1.0, v205
    v_add_f32 v206, 1.0, v206
    v_add_f32 v207, 1.0, v207
    v_rcp_f32 v204, v204
    v_mfma_f32_32x32x16_bf16 v[80:95], v[132:135], v[180:183], v[80:95]
    v_rcp_f32 v205, v205
    v_rcp_f32 v206, v206
    v_rcp_f32 v207, v207
    v_pk_mul_f32 v[100:101], v[100:101], v[204:205]
    v_pk_mul_f32 v[102:103], v[102:103], v[206:207]
    v_cvt_pk_bf16_f32 v98, v100, v101
    v_cvt_pk_bf16_f32 v99, v102, v103
k2_qe22:
    s_cmp_le_u32 s81, 16
    s_cbranch_scc1 k2_qs23
    v_exp_f32 v200, v104
    v_mfma_f32_32x32x16_bf16 v[80:95], v[196:199], v[152:155], v[80:95]
    v_exp_f32 v201, v105
    v_exp_f32 v202, v106
    v_exp_f32 v203, v107
    v_add_f32 v200, 1.0, v200
    v_add_f32 v201, 1.0, v201
    v_add_f32 v202, 1.0, v202
    v_add_f32 v203, 1.0, v203
    v_rcp_f32 v200, v200
    v_rcp_f32 v201, v201
    v_rcp_f32 v202, v202
    v_rcp_f32 v203, v203
    v_pk_mul_f32 v[104:105], v[104:105], v[200:201]
    v_pk_mul_f32 v[106:107], v[106:107], v[202:203]
    v_cvt_pk_bf16_f32 v100, v104, v105
    v_cvt_pk_bf16_f32 v101, v106, v107
k2_qe23:
    s_cmp_le_u32 s81, 24
    s_cbranch_scc1 k2_qs24
    v_exp_f32 v204, v108
    v_mfma_f32_32x32x16_bf16 v[80:95], v[192:195], v[168:171], v[80:95]
    v_exp_f32 v205, v109
    v_exp_f32 v206, v110
    v_exp_f32 v207, v111
    v_add_f32 v204, 1.0, v204
    v_add_f32 v205, 1.0, v205
    v_add_f32 v206, 1.0, v206
    v_add_f32 v207, 1.0, v207
    v_rcp_f32 v204, v204
    v_rcp_f32 v205, v205
    v_rcp_f32 v206, v206
    v_rcp_f32 v207, v207
    v_pk_mul_f32 v[108:109], v[108:109], v[204:205]
    v_pk_mul_f32 v[110:111], v[110:111], v[206:207]
    v_cvt_pk_bf16_f32 v102, v108, v109
    v_cvt_pk_bf16_f32 v103, v110, v111
k2_qe24:
    s_nop 10
    v_exp_f32 v200, v80
    v_mfma_f32_32x32x16_bf16 v[32:47], v[184:187], v[96:99], v[32:47]
    v_exp_f32 v201, v81
    v_exp_f32 v202, v82
    v_exp_f32 v203, v83
    v_add_f32 v200, 1.0, v200
    v_add_f32 v201, 1.0, v201
    v_add_f32 v202, 1.0, v202
    v_add_f32 v203, 1.0, v203
    v_rcp_f32 v200, v200
    v_mfma_f32_32x32x16_bf16 v[32:47], v[188:191], v[100:103], v[32:47]
    v_rcp_f32 v201, v201
    v_rcp_f32 v202, v202
    v_rcp_f32 v203, v203
    v_pk_mul_f32 v[80:81], v[80:81], v[200:201]
    v_pk_mul_f32 v[82:83], v[82:83], v[202:203]
    v_cvt_pk_bf16_f32 v80, v80, v81
    v_cvt_pk_bf16_f32 v81, v82, v83
    s_cmp_le_u32 s81, 8
    s_cbranch_scc1 k2_qs26
    v_exp_f32 v204, v84
    v_mfma_f32_32x32x16_bf16 v[96:111], v[136:139], v[176:179], 0
    v_exp_f32 v205, v85
    v_exp_f32 v206, v86
    v_exp_f32 v207, v87
    v_add_f32 v204, 1.0, v204
    v_add_f32 v205, 1.0, v205
    v_add_f32 v206, 1.0, v206
    v_add_f32 v207, 1.0, v207
    v_rcp_f32 v204, v204
    v_mfma_f32_32x32x16_bf16 v[96:111], v[140:143], v[180:183], v[96:111]
    v_rcp_f32 v205, v205
    v_rcp_f32 v206, v206
    v_rcp_f32 v207, v207
    v_pk_mul_f32 v[84:85], v[84:85], v[204:205]
    v_pk_mul_f32 v[86:87], v[86:87], v[206:207]
    v_cvt_pk_bf16_f32 v82, v84, v85
    v_cvt_pk_bf16_f32 v83, v86, v87
k2_qe26:
    s_waitcnt vmcnt(0) lgkmcnt(0)
    ds_read_b128 v[112:115], v5 offset:0
    ds_read_b128 v[116:119], v5 offset:32
    ds_read_b128 v[120:123], v5 offset:64
    ds_read_b128 v[124:127], v5 offset:96
    ds_read_b128 v[128:131], v5 offset:128
    ds_read_b128 v[132:135], v5 offset:160
    ds_read_b128 v[136:139], v5 offset:192
    ds_read_b128 v[140:143], v5 offset:224
    v_and_b32 v10, 0x80, v220
    v_mul_u32_u24 v10, 0x7f, v10
    v_lshl_or_b32 v10, v218, 16, v10
    v_cndmask_b32 v216, v10, v219, s[64:65]
    v_and_b32 v11, 7, v220
    v_lshl_add_u32 v14, v11, 6, v3
    v_lshl_add_u32 v11, v11, 4, v247
    v_cndmask_b32 v217, v11, v248, s[64:65]
    v_lshrrev_b32 v11, 16, v218
    v_cndmask_b32 v222, 0, v11, s[64:65]
    s_cmp_le_u32 s81, 16
    s_cbranch_scc1 k2_qs27
    v_exp_f32 v200, v88
    v_mfma_f32_32x32x16_bf16 v[96:111], v[196:199], v[156:159], v[96:111]
    v_exp_f32 v201, v89
    v_exp_f32 v202, v90
    v_exp_f32 v203, v91
    v_add_f32 v200, 1.0, v200
    v_add_f32 v201, 1.0, v201
    v_add_f32 v202, 1.0, v202
    v_add_f32 v203, 1.0, v203
    v_rcp_f32 v200, v200
    v_rcp_f32 v201, v201
    v_rcp_f32 v202, v202
    v_rcp_f32 v203, v203
    v_pk_mul_f32 v[88:89], v[88:89], v[200:201]
    v_pk_mul_f32 v[90:91], v[90:91], v[202:203]
    v_cvt_pk_bf16_f32 v84, v88, v89
    v_cvt_pk_bf16_f32 v85, v90, v91
k2_qe27:
    s_cmp_le_u32 s81, 24
    s_cbranch_scc1 k2_qs28
    v_exp_f32 v204, v92
    v_mfma_f32_32x32x16_bf16 v[96:111], v[192:195], v[172:175], v[96:111]
    v_exp_f32 v205, v93
    v_exp_f32 v206, v94
    v_exp_f32 v207, v95
    v_add_f32 v204, 1.0, v204
    v_add_f32 v205, 1.0, v205
    v_add_f32 v206, 1.0, v206
    v_add_f32 v207, 1.0, v207
    v_rcp_f32 v204, v204
    v_rcp_f32 v205, v205
    v_rcp_f32 v206, v206
    v_rcp_f32 v207, v207
    v_pk_mul_f32 v[92:93], v[92:93], v[204:205]
    v_pk_mul_f32 v[94:95], v[94:95], v[206:207]
    v_cvt_pk_bf16_f32 v86, v92, v93
    v_cvt_pk_bf16_f32 v87, v94, v95
k2_qe28:
    ds_read_b128 v[196:199], v8
    ds_read_b128 v[192:195], v217
    s_and_b32 s88, s6, 0x3ff
    s_lshl_b32 s88, s88, 2
    v_add_u32 v10, s88, v2
    ds_read_b128 v[208:211], v10
    ds_read_b128 v[212:215], v10 offset:16
    v_add_u32 v12, s88, v242
    ds_read_b32 v221, v12
    s_xor_b32 s88, s94, s78
    s_and_b32 s88, s88, 0x70000
    s_cbranch_scc1 k2_wdag
k2_wdarg:
    v_exp_f32 v200, v96
    v_mfma_f32_32x32x16_bf16 v[48:63], v[184:187], v[80:83], v[48:63]
    v_exp_f32 v201, v97
    v_exp_f32 v202, v98
    v_exp_f32 v203, v99
    v_add_f32 v200, 1.0, v200
    v_add_f32 v201, 1.0, v201
    v_add_f32 v202, 1.0, v202
    v_add_f32 v203, 1.0, v203
    v_rcp_f32 v200, v200
    v_mfma_f32_32x32x16_bf16 v[48:63], v[188:191], v[84:87], v[48:63]
    v_rcp_f32 v201, v201
    v_rcp_f32 v202, v202
    v_rcp_f32 v203, v203
    v_pk_mul_f32 v[96:97], v[96:97], v[200:201]
    v_pk_mul_f32 v[98:99], v[98:99], v[202:203]
    v_cvt_pk_bf16_f32 v96, v96, v97
    v_cvt_pk_bf16_f32 v97, v98, v99
    s_waitcnt lgkmcnt(0)
    v_or_b32 v192, v192, v222
    s_bitcmp1_b32 s6, 20
    s_cbranch_scc0 k2_lateg
    s_mov_b32 m0, s39
    v_lshl_add_u32 v11, v221, 5, v245
    buffer_load_dwordx4 v11, s[48:51], 0 offen lds
    s_add_u32 m0, s87, 0
    v_add_u32 v208, v6, v208
    buffer_load_dwordx4 v208, s[44:47], s86 offen lds
    s_add_u32 m0, s87, 1040
    v_add_u32 v209, v6, v209
    buffer_load_dwordx4 v209, s[44:47], s86 offen lds
    s_add_u32 m0, s87, 2080
    v_add_u32 v210, v6, v210
    buffer_load_dwordx4 v210, s[44:47], s86 offen lds
    s_add_u32 m0, s87, 3120
    v_add_u32 v211, v6, v211
    buffer_load_dwordx4 v211, s[44:47], s86 offen lds
    s_add_u32 m0, s87, 4160
    v_add_u32 v212, v6, v212
    buffer_load_dwordx4 v212, s[44:47], s86 offen lds
    s_add_u32 m0, s87, 5200
    v_add_u32 v213, v6, v213
    buffer_load_dwordx4 v213, s[44:47], s86 offen lds
    s_add_u32 m0, s87, 6240
    v_add_u32 v214, v6, v214
    buffer_load_dwordx4 v214, s[44:47], s86 offen lds
    s_add_u32 m0, s87, 7280
    v_add_u32 v215, v6, v215
    buffer_load_dwordx4 v215, s[44:47], s86 offen lds
k2_nx3g:
    s_cmp_le_u32 s81, 8
    s_cbranch_scc1 k2_qs30
    v_exp_f32 v204, v100
    v_mfma_f32_32x32x16_bf16 v[80:95], v[112:115], v[176:179], 0
    v_exp_f32 v205, v101
    v_exp_f32 v206, v102
    v_exp_f32 v207, v103
    v_add_f32 v204, 1.0, v204
    v_add_f32 v205, 1.0, v205
    v_add_f32 v206, 1.0, v206
    v_add_f32 v207, 1.0, v207
    v_rcp_f32 v204, v204
    v_mfma_f32_32x32x16_bf16 v[80:95], v[116:119], v[180:183], v[80:95]
    v_rcp_f32 v205, v205
    v_rcp_f32 v206, v206
    v_rcp_f32 v207, v207
    v_pk_mul_f32 v[100:101], v[100:101], v[204:205]
    v_pk_mul_f32 v[102:103], v[102:103], v[206:207]
    v_cvt_pk_bf16_f32 v98, v100, v101
    v_cvt_pk_bf16_f32 v99, v102, v103
k2_qe30:
    s_cmp_le_u32 s81, 16
    s_cbranch_scc1 k2_qs31
    v_exp_f32 v200, v104
    v_mfma_f32_32x32x16_bf16 v[80:95], v[196:199], v[144:147], v[80:95]
    v_exp_f32 v201, v105
    v_exp_f32 v202, v106
    v_exp_f32 v203, v107
    v_add_f32 v200, 1.0, v200
    v_add_f32 v201, 1.0, v201
    v_add_f32 v202, 1.0, v202
    v_add_f32 v203, 1.0, v203
    v_rcp_f32 v200, v200
    v_rcp_f32 v201, v201
    v_rcp_f32 v202, v202
    v_rcp_f32 v203, v203
    v_pk_mul_f32 v[104:105], v[104:105], v[200:201]
    v_pk_mul_f32 v[106:107], v[106:107], v[202:203]
    v_cvt_pk_bf16_f32 v100, v104, v105
    v_cvt_pk_bf16_f32 v101, v106, v107
k2_qe31:
    s_cmp_le_u32 s81, 24
    s_cbranch_scc1 k2_qs32
    v_exp_f32 v204, v108
    v_mfma_f32_32x32x16_bf16 v[80:95], v[192:195], v[160:163], v[80:95]
    v_exp_f32 v205, v109
    v_exp_f32 v206, v110
    v_exp_f32 v207, v111
    v_add_f32 v204, 1.0, v204
    v_add_f32 v205, 1.0, v205
    v_add_f32 v206, 1.0, v206
    v_add_f32 v207, 1.0, v207
    v_rcp_f32 v204, v204
    v_rcp_f32 v205, v205
    v_rcp_f32 v206, v206
    v_rcp_f32 v207, v207
    v_pk_mul_f32 v[108:109], v[108:109], v[204:205]
    v_pk_mul_f32 v[110:111], v[110:111], v[206:207]
    v_cvt_pk_bf16_f32 v102, v108, v109
    v_cvt_pk_bf16_f32 v103, v110, v111
k2_qe32:
    s_branch k2_rot
k2_flush:
    s_bfe_u32 s91, s13, 0x30010
    v_and_b32 v10, 31, v1
    v_lshrrev_b32 v11, 5, v1
    v_lshrrev_b32 v12, 2, v10
    s_lshl_b32 s88, s5, 4
    v_add_u32 v12, s88, v12
    v_xor_b32 v12, v12, v11
    v_lshlrev_b32 v12, 4, v12
    v_lshl_add_u32 v12, v11, 9, v12
    v_and_b32 v13, 3, v10
    v_lshl_add_u32 v12, v13, 2, v12
    s_and_b32 s88, s91, 1
    s_lshl_b32 s88, s88, 7
    v_xor_b32 v12, s88, v12
    s_lshl_b32 s88, s91, 12
    s_add_u32 s88, s88, 128512
    s_lshl_b32 s89, s4, 12
    s_add_u32 s89, s89, 144896
    s_cmp_eq_u32 s14, 1
    s_cselect_b32 s88, s89, s88
    v_add_u32 v12, s88, v12
    s_mov_b32 s89, 0xbf317218
    v_mul_f32 v16, s89, v16
    v_mul_f32 v32, s89, v32
    v_mul_f32 v20, s89, v20
    v_mul_f32 v36, s89, v36
    v_mul_f32 v24, s89, v24
    v_mul_f32 v40, s89, v40
    v_mul_f32 v28, s89, v28
    v_mul_f32 v44, s89, v44
    v_mul_f32 v48, s89, v48
    v_mul_f32 v64, s89, v64
    v_mul_f32 v52, s89, v52
    v_mul_f32 v68, s89, v68
    v_mul_f32 v56, s89, v56
    v_mul_f32 v72, s89, v72
    v_mul_f32 v60, s89, v60
    v_mul_f32 v76, s89, v76
    v_xor_b32 v200, 0, v12
    v_xor_b32 v204, 128, v12
    v_xor_b32 v201, 32, v12
    v_xor_b32 v205, 160, v12
    v_xor_b32 v202, 64, v12
    v_xor_b32 v206, 192, v12
    v_xor_b32 v203, 96, v12
    v_xor_b32 v207, 224, v12
    v_cvt_pk_bf16_f32 v16, v16, v32
    v_cvt_pk_bf16_f32 v20, v20, v36
    v_cvt_pk_bf16_f32 v24, v24, v40
    v_cvt_pk_bf16_f32 v28, v28, v44
    v_cvt_pk_bf16_f32 v48, v48, v64
    v_cvt_pk_bf16_f32 v52, v52, v68
    v_cvt_pk_bf16_f32 v56, v56, v72
    v_cvt_pk_bf16_f32 v60, v60, v76
    ds_write_b32 v200, v16 offset:0
    ds_write_b32 v201, v20 offset:1024
    ds_write_b32 v202, v24 offset:2048
    ds_write_b32 v203, v28 offset:3072
    ds_write_b32 v204, v48 offset:0
    ds_write_b32 v205, v52 offset:1024
    ds_write_b32 v206, v56 offset:2048
    ds_write_b32 v207, v60 offset:3072
    v_pk_mul_f32 v[16:17], v[16:17], v[224:225] op_sel:[0,0] op_sel_hi:[1,0]
    v_pk_mul_f32 v[18:19], v[18:19], v[224:225] op_sel:[0,0] op_sel_hi:[1,0]
    v_pk_mul_f32 v[20:21], v[20:21], v[224:225] op_sel:[0,0] op_sel_hi:[1,0]
    v_pk_mul_f32 v[22:23], v[22:23], v[224:225] op_sel:[0,0] op_sel_hi:[1,0]
    v_pk_mul_f32 v[24:25], v[24:25], v[224:225] op_sel:[0,0] op_sel_hi:[1,0]
    v_pk_mul_f32 v[26:27], v[26:27], v[224:225] op_sel:[0,0] op_sel_hi:[1,0]
    v_pk_mul_f32 v[28:29], v[28:29], v[224:225] op_sel:[0,0] op_sel_hi:[1,0]
    v_pk_mul_f32 v[30:31], v[30:31], v[224:225] op_sel:[0,0] op_sel_hi:[1,0]
    v_pk_fma_f32 v[16:17], v[32:33], v[224:225], v[16:17] op_sel:[0,1,0] op_sel_hi:[1,1,1]
    v_pk_fma_f32 v[18:19], v[34:35], v[224:225], v[18:19] op_sel:[0,1,0] op_sel_hi:[1,1,1]
    v_pk_fma_f32 v[20:21], v[36:37], v[224:225], v[20:21] op_sel:[0,1,0] op_sel_hi:[1,1,1]
    v_pk_fma_f32 v[22:23], v[38:39], v[224:225], v[22:23] op_sel:[0,1,0] op_sel_hi:[1,1,1]
    v_pk_fma_f32 v[24:25], v[40:41], v[224:225], v[24:25] op_sel:[0,1,0] op_sel_hi:[1,1,1]
    v_pk_fma_f32 v[26:27], v[42:43], v[224:225], v[26:27] op_sel:[0,1,0] op_sel_hi:[1,1,1]
    v_pk_fma_f32 v[28:29], v[44:45], v[224:225], v[28:29] op_sel:[0,1,0] op_sel_hi:[1,1,1]
    v_pk_fma_f32 v[30:31], v[46:47], v[224:225], v[30:31] op_sel:[0,1,0] op_sel_hi:[1,1,1]
    v_pk_fma_f32 v[16:17], v[48:49], v[226:227], v[16:17] op_sel:[0,0,0] op_sel_hi:[1,0,1]
    v_pk_fma_f32 v[18:19], v[50:51], v[226:227], v[18:19] op_sel:[0,0,0] op_sel_hi:[1,0,1]
    v_pk_fma_f32 v[20:21], v[52:53], v[226:227], v[20:21] op_sel:[0,0,0] op_sel_hi:[1,0,1]
    v_pk_fma_f32 v[22:23], v[54:55], v[226:227], v[22:23] op_sel:[0,0,0] op_sel_hi:[1,0,1]
    v_pk_fma_f32 v[24:25], v[56:57], v[226:227], v[24:25] op_sel:[0,0,0] op_sel_hi:[1,0,1]
    v_pk_fma_f32 v[26:27], v[58:59], v[226:227], v[26:27] op_sel:[0,0,0] op_sel_hi:[1,0,1]
    v_pk_fma_f32 v[28:29], v[60:61], v[226:227], v[28:29] op_sel:[0,0,0] op_sel_hi:[1,0,1]
    v_pk_fma_f32 v[30:31], v[62:63], v[226:227], v[30:31] op_sel:[0,0,0] op_sel_hi:[1,0,1]
    v_pk_fma_f32 v[16:17], v[64:65], v[226:227], v[16:17] op_sel:[0,1,0] op_sel_hi:[1,1,1]
    v_pk_fma_f32 v[18:19], v[66:67], v[226:227], v[18:19] op_sel:[0,1,0] op_sel_hi:[1,1,1]
    v_pk_fma_f32 v[20:21], v[68:69], v[226:227], v[20:21] op_sel:[0,1,0] op_sel_hi:[1,1,1]
    v_pk_fma_f32 v[22:23], v[70:71], v[226:227], v[22:23] op_sel:[0,1,0] op_sel_hi:[1,1,1]
    v_pk_fma_f32 v[24:25], v[72:73], v[226:227], v[24:25] op_sel:[0,1,0] op_sel_hi:[1,1,1]
    v_pk_fma_f32 v[26:27], v[74:75], v[226:227], v[26:27] op_sel:[0,1,0] op_sel_hi:[1,1,1]
    v_pk_fma_f32 v[28:29], v[76:77], v[226:227], v[28:29] op_sel:[0,1,0] op_sel_hi:[1,1,1]
    v_pk_fma_f32 v[30:31], v[78:79], v[226:227], v[30:31] op_sel:[0,1,0] op_sel_hi:[1,1,1]
    v_permlane16_swap_b32 v17, v18
    v_permlane16_swap_b32 v19, v21
    v_permlane16_swap_b32 v22, v23
    v_permlane16_swap_b32 v25, v26
    v_permlane16_swap_b32 v27, v29
    v_permlane16_swap_b32 v30, v31
    v_add_f32 v17, v17, v18
    v_add_f32 v19, v19, v21
    v_add_f32 v22, v22, v23
    v_add_f32 v25, v25, v26
    v_add_f32 v27, v27, v29
    v_add_f32 v30, v30, v31
    v_add_f32_dpp v18, v17, v17 row_ror:8 row_mask:0xf bank_mask:0x3
    v_add_f32_dpp v21, v22, v22 row_ror:8 row_mask:0xf bank_mask:0x3
    v_add_f32_dpp v23, v27, v27 row_ror:8 row_mask:0xf bank_mask:0x3
    v_add_f32_dpp v18, v19, v19 row_ror:8 row_mask:0xf bank_mask:0xc
    v_add_f32_dpp v21, v25, v25 row_ror:8 row_mask:0xf bank_mask:0xc
    v_add_f32_dpp v23, v30, v30 row_ror:8 row_mask:0xf bank_mask:0xc
    v_add_f32_dpp v26, v18, v18 row_half_mirror row_mask:0xf bank_mask:0x5
    s_nop 0
    v_add_f32_dpp v29, v23, v23 row_half_mirror row_mask:0xf bank_mask:0xf
    v_add_f32_dpp v26, v21, v21 row_half_mirror row_mask:0xf bank_mask:0xa
    s_nop 1
    v_add_f32_dpp v26, v26, v26 quad_perm:[1,0,3,2] row_mask:0xf bank_mask:0xf
    v_add_f32_dpp v29, v29, v29 quad_perm:[1,0,3,2] row_mask:0xf bank_mask:0xf
    s_nop 0
    v_add_f32_dpp v26, v26, v26 quad_perm:[2,3,0,1] row_mask:0xf bank_mask:0xf
    v_add_f32_dpp v29, v29, v29 quad_perm:[2,3,0,1] row_mask:0xf bank_mask:0xf
    s_mul_i32 s88, s91, 192
    s_add_u32 s88, s88, 161280
    s_mul_i32 s89, s4, 192
    s_add_u32 s89, s89, 162048
    s_cmp_eq_u32 s14, 1
    s_cselect_b32 s88, s89, s88
    s_mul_i32 s89, s5, 96
    s_add_u32 s88, s88, s89
    v_add_u32 v12, s88, v240
    v_add_u32 v13, s88, v241
    s_mov_b32 exec_lo, 0x11111111
    s_mov_b32 exec_hi, 0x11111111
    ds_write_b32 v12, v26
    s_mov_b32 exec_lo, 0x01010101
    s_mov_b32 exec_hi, 0x01010101
    ds_write_b32 v13, v29
    s_mov_b64 exec, -1
    v_pk_mov_b32 v[16:17], 0, 0
    v_pk_mov_b32 v[18:19], 0, 0
    v_pk_mov_b32 v[20:21], 0, 0
    v_pk_mov_b32 v[22:23], 0, 0
    v_pk_mov_b32 v[24:25], 0, 0
    v_pk_mov_b32 v[26:27], 0, 0
    v_pk_mov_b32 v[28:29], 0, 0
    v_pk_mov_b32 v[30:31], 0, 0
    v_pk_mov_b32 v[32:33], 0, 0
    v_pk_mov_b32 v[34:35], 0, 0
    v_pk_mov_b32 v[36:37], 0, 0
    v_pk_mov_b32 v[38:39], 0, 0
    v_pk_mov_b32 v[40:41], 0, 0
    v_pk_mov_b32 v[42:43], 0, 0
    v_pk_mov_b32 v[44:45], 0, 0
    v_pk_mov_b32 v[46:47], 0, 0
    v_pk_mov_b32 v[48:49], 0, 0
    v_pk_mov_b32 v[50:51], 0, 0
    v_pk_mov_b32 v[52:53], 0, 0
    v_pk_mov_b32 v[54:55], 0, 0
    v_pk_mov_b32 v[56:57], 0, 0
    v_pk_mov_b32 v[58:59], 0, 0
    v_pk_mov_b32 v[60:61], 0, 0
    v_pk_mov_b32 v[62:63], 0, 0
    v_pk_mov_b32 v[64:65], 0, 0
    v_pk_mov_b32 v[66:67], 0, 0
    v_pk_mov_b32 v[68:69], 0, 0
    v_pk_mov_b32 v[70:71], 0, 0
    v_pk_mov_b32 v[72:73], 0, 0
    v_pk_mov_b32 v[74:75], 0, 0
    v_pk_mov_b32 v[76:77], 0, 0
    v_pk_mov_b32 v[78:79], 0, 0
    s_bitcmp1_b32 s78, 21
    s_cbranch_scc1 k2_noflf
    s_branch k2_noflg
k2_qs18:
    v_mov_b32 v82, 0
    v_mov_b32 v83, 0
    v_mfma_f32_32x32x16_bf16 v[96:111], v[120:123], v[176:179], 0
    v_mfma_f32_32x32x16_bf16 v[96:111], v[124:127], v[180:183], v[96:111]
    s_branch k2_qe18
k2_qs19:
    v_mov_b32 v84, 0
    v_mov_b32 v85, 0
    v_mfma_f32_32x32x16_bf16 v[96:111], v[196:199], v[148:151], v[96:111]
    s_branch k2_qe19
k2_qs20:
    v_mov_b32 v86, 0
    v_mov_b32 v87, 0
    v_mfma_f32_32x32x16_bf16 v[96:111], v[192:195], v[164:167], v[96:111]
    s_branch k2_qe20
k2_qs22:
    v_mov_b32 v98, 0
    v_mov_b32 v99, 0
    v_mfma_f32_32x32x16_bf16 v[80:95], v[128:131], v[176:179], 0
    v_mfma_f32_32x32x16_bf16 v[80:95], v[132:135], v[180:183], v[80:95]
    s_branch k2_qe22
k2_qs23:
    v_mov_b32 v100, 0
    v_mov_b32 v101, 0
    v_mfma_f32_32x32x16_bf16 v[80:95], v[196:199], v[152:155], v[80:95]
    s_branch k2_qe23
k2_qs24:
    v_mov_b32 v102, 0
    v_mov_b32 v103, 0
    v_mfma_f32_32x32x16_bf16 v[80:95], v[192:195], v[168:171], v[80:95]
    s_branch k2_qe24
k2_qs26:
    v_mov_b32 v82, 0
    v_mov_b32 v83, 0
    v_mfma_f32_32x32x16_bf16 v[96:111], v[136:139], v[176:179], 0
    v_mfma_f32_32x32x16_bf16 v[96:111], v[140:143], v[180:183], v[96:111]
    s_branch k2_qe26
k2_qs27:
    v_mov_b32 v84, 0
    v_mov_b32 v85, 0
    v_mfma_f32_32x32x16_bf16 v[96:111], v[196:199], v[156:159], v[96:111]
    s_branch k2_qe27
k2_qs28:
    v_mov_b32 v86, 0
    v_mov_b32 v87, 0
    v_mfma_f32_32x32x16_bf16 v[96:111], v[192:195], v[172:175], v[96:111]
    s_branch k2_qe28
k2_wdag:
    s_bfe_u32 s88, s94, 0x30010
    s_lshl_b32 s88, s88, 12
    v_add_u32 v10, s88, v9
    s_mov_b32 exec_hi, 0
    ds_read_b128 v[160:163], v10 offset:0
    ds_read_b128 v[164:167], v10 offset:512
    ds_read_b128 v[168:171], v10 offset:1024
    ds_read_b128 v[172:175], v10 offset:1536
    s_mov_b32 exec_hi, -1
    s_branch k2_wdarg
k2_lateg:
    s_cmp_eq_u32 s12, 0
    s_cbranch_scc0 k2_late2g
    s_mov_b32 s12, 1
    v_lshrrev_b32 v13, 5, v1
    s_mul_i32 s89, s3, 6
    v_add_u32 v13, s89, v13
    v_and_b32 v10, 31, v1
    s_mul_i32 s90, s2, 40
    v_and_b32 v11, 15, v13
    v_xor_b32 v11, v11, v10
    v_lshlrev_b32 v11, 4, v11
    v_add_u32 v12, s90, v13
    v_lshl_add_u32 v11, v12, 9, v11
    s_and_b32 s91, s3, 1
    s_lshl_b32 s91, s91, 7
    s_add_u32 s91, s91, s87
    s_add_u32 m0, s91, 0
    s_nop 0
    buffer_load_dwordx4 v11, s[56:59], 0 offen lds
    v_add_u32 v13, 2, v13
    v_and_b32 v11, 15, v13
    v_xor_b32 v11, v11, v10
    v_lshlrev_b32 v11, 4, v11
    v_add_u32 v12, s90, v13
    v_lshl_add_u32 v11, v12, 9, v11
    s_and_b32 s91, s3, 1
    s_lshl_b32 s91, s91, 7
    s_add_u32 s91, s91, s87
    s_add_u32 m0, s91, 1024
    s_nop 0
    buffer_load_dwordx4 v11, s[56:59], 0 offen lds
    v_add_u32 v13, 2, v13
    v_and_b32 v11, 15, v13
    v_xor_b32 v11, v11, v10
    v_lshlrev_b32 v11, 4, v11
    v_add_u32 v12, s90, v13
    v_lshl_add_u32 v11, v12, 9, v11
    s_and_b32 s91, s3, 1
    s_lshl_b32 s91, s91, 7
    s_add_u32 s91, s91, s87
    s_add_u32 m0, s91, 2048
    s_nop 0
    buffer_load_dwordx4 v11, s[56:59], 0 offen lds
k2_late2g:
    s_bitcmp1_b32 s94, 20
    s_cbranch_scc1 k2_nx3g
    v_lshlrev_b32 v12, 4, v1
    s_lshl_b32 s88, s3, 15
    s_add_u32 s88, s88, 16121856
    s_add_u32 s89, s88, 0
    buffer_load_dwordx4 v[112:115], v12, s[40:43], s89 offen
    s_add_u32 s89, s88, 1024
    buffer_load_dwordx4 v[116:119], v12, s[40:43], s89 offen
    s_add_u32 s89, s88, 2048
    buffer_load_dwordx4 v[120:123], v12, s[40:43], s89 offen
    s_add_u32 s89, s88, 3072
    buffer_load_dwordx4 v[124:127], v12, s[40:43], s89 offen
    s_add_u32 s89, s88, 4096
    buffer_load_dwordx4 v[128:131], v12, s[40:43], s89 offen
    s_add_u32 s89, s88, 5120
    buffer_load_dwordx4 v[132:135], v12, s[40:43], s89 offen
    s_add_u32 s89, s88, 6144
    buffer_load_dwordx4 v[136:139], v12, s[40:43], s89 offen
    s_add_u32 s89, s88, 7168
    buffer_load_dwordx4 v[140:143], v12, s[40:43], s89 offen
    s_add_u32 s89, s88, 8192
    buffer_load_dwordx4 v[144:147], v12, s[40:43], s89 offen
    s_add_u32 s89, s88, 9216
    buffer_load_dwordx4 v[148:151], v12, s[40:43], s89 offen
    s_add_u32 s89, s88, 10240
    buffer_load_dwordx4 v[152:155], v12, s[40:43], s89 offen
    s_add_u32 s89, s88, 11264
    buffer_load_dwordx4 v[156:159], v12, s[40:43], s89 offen
    s_add_u32 s89, s88, 12288
    buffer_load_dwordx4 v[160:163], v12, s[40:43], s89 offen
    s_add_u32 s89, s88, 13312
    buffer_load_dwordx4 v[164:167], v12, s[40:43], s89 offen
    s_add_u32 s89, s88, 14336
    buffer_load_dwordx4 v[168:171], v12, s[40:43], s89 offen
    s_add_u32 s89, s88, 15360
    buffer_load_dwordx4 v[172:175], v12, s[40:43], s89 offen
    s_branch k2_nx3g
k2_qs30:
    v_mov_b32 v98, 0
    v_mov_b32 v99, 0
    v_mfma_f32_32x32x16_bf16 v[80:95], v[112:115], v[176:179], 0
    v_mfma_f32_32x32x16_bf16 v[80:95], v[116:119], v[180:183], v[80:95]
    s_branch k2_qe30
k2_qs31:
    v_mov_b32 v100, 0
    v_mov_b32 v101, 0
    v_mfma_f32_32x32x16_bf16 v[80:95], v[196:199], v[144:147], v[80:95]
    s_branch k2_qe31
k2_qs32:
    v_mov_b32 v102, 0
    v_mov_b32 v103, 0
    v_mfma_f32_32x32x16_bf16 v[80:95], v[192:195], v[160:163], v[80:95]
    s_branch k2_qe32
.section .rodata,"a"
.p2align 6
.p2align 6
.amdhsa_kernel k1_prep_kernel
  .amdhsa_next_free_vgpr 256
  .amdhsa_next_free_sgpr 102
  .amdhsa_accum_offset 256
  .amdhsa_group_segment_fixed_size 0
  .amdhsa_kernarg_size 88
  .amdhsa_user_sgpr_count 2
  .amdhsa_user_sgpr_kernarg_segment_ptr 1
  .amdhsa_system_sgpr_workgroup_id_x 1
  .amdhsa_float_denorm_mode_32 3
  .amdhsa_float_denorm_mode_16_64 3
.end_amdhsa_kernel
.p2align 6
.amdhsa_kernel k2_main_kernel
  .amdhsa_next_free_vgpr 256
  .amdhsa_next_free_sgpr 102
  .amdhsa_accum_offset 256
  .amdhsa_group_segment_fixed_size 0
  .amdhsa_kernarg_size 88
  .amdhsa_user_sgpr_count 2
  .amdhsa_user_sgpr_kernarg_segment_ptr 1
  .amdhsa_system_sgpr_workgroup_id_x 1
  .amdhsa_float_denorm_mode_32 3
  .amdhsa_float_denorm_mode_16_64 3
.end_amdhsa_kernel
```
